```python
import torch

def _softmax(x, axis=-1):
    return torch.softmax(x, dim=axis)
def _gelu(x):
    return torch.nn.functional.gelu(x, approximate="tanh")
def _silu(x):
    return torch.nn.functional.silu(x)
def _sigmoid(x):
    return torch.sigmoid(x)
def _layernorm(x, axis=-1, eps=1e-5):
    m = x.mean(dim=axis, keepdim=True)
    v = x.var(dim=axis, keepdim=True, unbiased=False)
    return (x - m) / torch.sqrt(v + eps)
def _scatter_add(tgt, idx, src, axis=0):
    return tgt.clone().index_add_(axis, idx, src)
def _segment_sum(src, seg, n):
    out = torch.zeros((n,) + src.shape[1:], dtype=src.dtype)
    return out.index_add_(0, seg, src)
def _pad(x, pw):
    flat = tuple(v for pair in reversed(pw) for v in pair)
    return torch.nn.functional.pad(x, flat)

kernel_name = 'standalone__dcn_v2_cross__recsys'

def setup_inputs():

    _w = (lambda a: (lambda t: t.to(torch.bfloat16) if t.is_floating_point() else t)(torch.as_tensor(a)))
    B, F, D, L = 16384, 26, 16, 6
    Din = min(F * D, 1024)
    return {
        "x0": _w((lambda *s: torch.randn(*s, dtype=torch.bfloat16) * 0.05)(B, Din)),
        "ws": _w((lambda *s: torch.randn(*s, dtype=torch.bfloat16) * 0.05)(L, Din, Din)),
        "bs": _w((lambda *s: torch.randn(*s, dtype=torch.bfloat16) * 0.05)(L, Din)),
    }

def reference(x0, ws, bs):
    x = x0
    for l in range(ws.shape[0]):
        x = x0 * (x @ ws[l] + bs[l]) + x
    return x
```

```asm
; @launch grid=(256,1,1) block=(256,1,1) lds=163840
.amdgcn_target "amdgcn-amd-amdhsa--gfx950"
.text
.globl standalone__dcn_v2_cross__recsys_kernel
.p2align 8
.type standalone__dcn_v2_cross__recsys_kernel,@function
standalone__dcn_v2_cross__recsys_kernel:
    s_cmp_ge_u32 s2, 256
    s_cbranch_scc1 L_end
    s_load_dwordx8 s[4:11], s[0:1], 0
    s_load_dwordx4 s[12:15], s[0:1], 32
    v_lshrrev_b32 v5, 6, v0
    v_and_b32 v1, 63, v0
    v_readfirstlane_b32 s16, v5
    v_lshlrev_b32 v4, 4, v1
    v_and_b32 v7, 3, v1
    s_getpc_b64 s[28:29]
L_pc:
    s_lshr_b32 s46, s2, 3
    s_lshl_b32 s46, s46, 2
    s_add_u32 s46, s46, s16
    s_lshl_b32 s46, s46, 7
    v_and_b32 v27, 1, v0
    v_lshlrev_b32 v27, 14, v27
    v_add_u32 v27, s46, v27
    v_min_u32 v27, L_code_end-L_pc-4, v27
    global_load_dword v27, v27, s[28:29]
    s_lshr_b32 s46, s2, 3
    s_lshl_b32 s46, s46, 2
    s_add_u32 s46, s46, s16
    s_mul_i32 s47, s46, 2816
    v_min_u32 v25, 21, v1
    v_lshlrev_b32 v25, 7, v25
    v_add_u32 v25, s47, v25
    s_lshr_b32 s46, s2, 4
    s_lshl_b32 s46, s46, 2
    s_add_u32 s46, s46, s16
    s_mul_i32 s47, s46, 5504
    v_min_u32 v252, 42, v1
    v_lshlrev_b32 v252, 7, v252
    v_add_u32 v252, s47, v252
    s_lshr_b32 s38, s2, 4
    s_lshl_b32 s38, s38, 3
    s_and_b32 s39, s2, 7
    s_or_b32 s83, s38, s39
    v_lshrrev_b32 v5, 2, v1
    v_mul_u32_u24 v5, 832, v5
    v_lshl_add_u32 v5, v7, 4, v5
    s_lshl_b32 s84, s83, 2
    s_add_u32 s84, s84, s16
    s_lshl_b32 s84, s84, 1
    s_add_u32 s84, s84, 169
    s_sub_u32 s85, s84, 1014
    s_cmp_ge_u32 s84, 1014
    s_cselect_b32 s84, s85, s84
    s_mul_i32 s88, s84, 5042
    s_lshr_b32 s88, s88, 16
    s_mul_i32 s89, s88, 13
    s_sub_u32 s89, s84, s89
    s_mul_i32 s85, s88, 26624
    s_lshl_b32 s90, s89, 6
    s_add_u32 s85, s85, s90
    v_add_u32 v6, s85, v5
    v_add_u32 v8, 13312, v6
    s_lshl_b32 s92, s83, 2
    s_add_u32 s92, s92, s16
    s_lshl_b32 s92, s92, 1
    s_add_u32 s92, s92, 170
    s_sub_u32 s93, s92, 1014
    s_cmp_ge_u32 s92, 1014
    s_cselect_b32 s92, s93, s92
    s_mul_i32 s96, s92, 5042
    s_lshr_b32 s96, s96, 16
    s_mul_i32 s97, s96, 13
    s_sub_u32 s97, s92, s97
    s_mul_i32 s93, s96, 26624
    s_lshl_b32 s98, s97, 6
    s_add_u32 s93, s93, s98
    v_add_u32 v32, s93, v5
    v_add_u32 v33, 13312, v32
    s_and_b32 s24, s16, 1
    s_lshr_b32 s25, s16, 1
    s_mul_i32 s46, s24, 13312
    s_mul_i32 s47, s25, 6656
    s_add_u32 s46, s46, s47
    v_add_u32 v239, s46, v4
    s_mul_i32 s47, s25, 53256
    s_mul_i32 s35, s24, 6656
    s_add_u32 s35, s35, s47
    s_add_u32 s3, s35, 93184
    v_lshrrev_b32 v12, 3, v1
    v_mul_u32_u24 v255, 1664, v12
    v_and_b32 v13, 0x70, v4
    v_lshlrev_b32 v12, 1, v1
    v_and_b32 v12, 0x30, v12
    v_xor_b32 v13, v13, v12
    s_mul_i32 s34, s16, 13312
    s_mul_i32 s46, s2, 53248
    s_add_u32 s46, s46, s34
    v_add3_u32 v255, v255, v13, s46
    v_min_u32 v26, 207, v0
    v_lshlrev_b32 v26, 2, v26
    s_waitcnt lgkmcnt(0)
    global_load_dword v24, v25, s[6:7]
    s_bitcmp1_b32 s2, 3
    s_cbranch_scc1 L_var1
    s_add_u32 s8, s8, 2496
    s_addc_u32 s9, s9, 0
    global_load_dword v208, v26, s[8:9] offset:-2496
    global_load_dword v209, v26, s[8:9] offset:-1664
    global_load_dword v210, v26, s[8:9] offset:-832
    global_load_dword v211, v26, s[8:9] offset:0
    global_load_dword v212, v26, s[8:9] offset:832
    global_load_dword v213, v26, s[8:9] offset:1664
    s_add_u32 m0, s34, 0
    s_nop 0
    global_load_lds_dwordx4 v255, s[4:5] offset:0 nt
    s_add_u32 m0, s34, 5376
    s_nop 0
    global_load_lds_dwordx4 v255, s[4:5] offset:768 nt
    s_add_u32 m0, s34, 6272
    s_nop 0
    global_load_lds_dwordx4 v255, s[4:5] offset:896 nt
    s_add_u32 m0, s34, 896
    s_nop 0
    global_load_lds_dwordx4 v255, s[4:5] offset:128 nt
    s_add_u32 m0, s34, 7168
    s_nop 0
    global_load_lds_dwordx4 v255, s[4:5] offset:1024 nt
    s_add_u32 m0, s34, 1792
    s_nop 0
    global_load_lds_dwordx4 v255, s[4:5] offset:256 nt
    s_add_u32 m0, s34, 8064
    s_nop 0
    global_load_lds_dwordx4 v255, s[4:5] offset:1152 nt
    s_add_u32 m0, s34, 2688
    s_nop 0
    global_load_lds_dwordx4 v255, s[4:5] offset:384 nt
    s_add_u32 m0, s34, 8960
    s_nop 0
    global_load_lds_dwordx4 v255, s[4:5] offset:1280 nt
    s_add_u32 m0, s34, 3584
    s_nop 0
    global_load_lds_dwordx4 v255, s[4:5] offset:512 nt
    s_add_u32 m0, s34, 9856
    s_nop 0
    global_load_lds_dwordx4 v255, s[4:5] offset:1408 nt
    s_add_u32 m0, s34, 4480
    s_nop 0
    global_load_lds_dwordx4 v255, s[4:5] offset:640 nt
    s_add_u32 m0, s34, 10752
    s_nop 0
    global_load_lds_dwordx4 v255, s[4:5] offset:1536 nt
    v_and_b32 v2, 15, v0
    v_lshrrev_b32 v3, 4, v1
    v_lshrrev_b32 v13, 2, v2
    v_lshl_add_u32 v11, v3, 3, v13
    v_lshlrev_b32 v11, 6, v11
    v_lshl_add_u32 v11, v7, 4, v11
    v_add_u32 v11, s3, v11
    s_lshl_b32 s43, s16, 6
    s_lshl_b32 s44, s25, 3
    v_and_b32 v14, 1, v3
    v_mul_u32_u24 v253, 53256, v14
    v_lshrrev_b32 v14, 1, v3
    v_mul_u32_u24 v14, 6656, v14
    v_mul_u32_u24 v13, 832, v13
    v_add3_u32 v253, v253, v14, v13
    v_lshl_add_u32 v253, v7, 4, v253
    s_add_u32 s45, s44, 54016
    v_add_u32 v254, s45, v253
    s_add_u32 s45, s43, 53248
    v_add_u32 v253, s45, v253
    v_and_b32 v13, 1, v2
    v_lshl_add_u32 v14, v13, 2, v3
    v_bfe_u32 v15, v2, 1, 2
    v_xor_b32 v14, v14, v15
    v_lshlrev_b32 v14, 4, v14
    v_lshrrev_b32 v15, 1, v2
    v_lshl_add_u32 v14, v15, 7, v14
    v_mul_u32_u24 v15, 6144, v13
    v_add_u32 v14, v14, v15
    v_xor_b32 v15, 64, v14
    v_lshl_add_u32 v15, v13, 10, v15
    s_mul_i32 s45, s24, 26624
    s_sub_u32 s46, 26624, s45
    v_add_u32 v214, s45, v14
    v_add_u32 v215, s46, v14
    v_add_u32 v216, s45, v15
    v_add_u32 v218, s46, v15
    s_cmp_eq_u32 s24, 1
    s_cselect_b64 vcc, -1, 0
    s_lshl_b32 s47, s25, 10
    v_cndmask_b32 v236, v214, v216, vcc
    v_cndmask_b32 v237, v215, v218, vcc
    v_add_u32 v236, s47, v236
    v_add_u32 v237, s47, v237
    v_add_u32 v238, s44, v214
    v_add_u32 v248, 106496, v236
    v_add_u32 v249, 106496, v237
    v_add_u32 v250, 106496, v238
    s_mul_i32 s26, s16, 66560
    s_sub_u32 s26, 106496, s26
    s_lshl_b32 s45, s24, 11
    s_sub_u32 s46, 2048, s45
    s_lshl_b32 s47, s16, 12
    v_add_u32 v240, s45, v4
    v_add_u32 v241, s46, v4
    v_add_u32 v242, s47, v240
    v_add_u32 v243, s47, v241
    s_add_u32 s45, s44, 49152
    v_add_u32 v244, s45, v240
    v_lshlrev_b32 v245, 5, v3
    s_lshl_b32 s45, s25, 4
    s_add_u32 s45, s45, 68096
    v_add_u32 v251, s45, v245
    s_lshl_b32 s45, s16, 7
    s_add_u32 s45, s45, 66560
    v_add_u32 v245, s45, v245
    s_mul_i32 s45, s25, 13312
    s_add_u32 s45, s45, 319488
    v_add_u32 v247, s45, v4
    s_mul_i32 s45, s16, 79872
    v_add_u32 v246, s45, v4
    s_add_u32 s22, s14, 352256
    s_addc_u32 s23, s15, 0
    s_mul_i32 s45, s16, 79872
    s_add_u32 s72, s14, s45
    s_addc_u32 s73, s15, 0
    s_and_b32 s73, s73, 0xffff
    s_or_b32 s73, s73, 0x100000
    s_mov_b32 s74, 2113536
    s_mov_b32 s75, 0x00800000
    s_mul_i32 s45, s25, 13312
    s_add_u32 s45, s45, 319488
    s_add_u32 s76, s14, s45
    s_addc_u32 s77, s15, 0
    s_and_b32 s77, s77, 0xffff
    s_or_b32 s77, s77, 0x100000
    s_mov_b32 s78, 2113536
    s_mov_b32 s79, 0x00800000
    s_mov_b32 s80, 352256
    s_mov_b64 s[18:19], s[22:23]
    s_mov_b64 s[20:21], s[22:23]
    s_mov_b64 s[36:37], s[22:23]
    s_cmp_eq_u32 s16, 0
    s_cselect_b32 s32, 15, 0
    s_cselect_b32 s30, 1, 0
    s_mov_b32 s33, 0
    v_lshlrev_b32 v222, 6, v7
    v_mov_b32 v221, 27
    v_mov_b32 v220, 1
    v_mov_b32 v224, 0x412a0000
    v_mov_b32 v225, 0x412a0000
    v_mov_b32 v226, 0x412a0000
    v_mov_b32 v227, 0x412a0000
    v_lshlrev_b32 v217, 3, v0
    v_add_u32 v217, 66560, v217
    s_mov_b32 s17, 4
    s_bitcmp1_b32 s2, 3
    s_cselect_b32 s0, 0, 24
    s_add_u32 m0, s35, 56320
    s_add_u32 s28, s6, 3072
    s_addc_u32 s29, s7, 0
    global_load_lds_dwordx4 v239, s[28:29] offset:-3072
    global_load_lds_dwordx4 v239, s[28:29] offset:-2048
    global_load_lds_dwordx4 v239, s[28:29] offset:-1024
    global_load_lds_dwordx4 v239, s[28:29] offset:0
    global_load_lds_dwordx4 v239, s[28:29] offset:1024
    global_load_lds_dwordx4 v239, s[28:29] offset:2048
    s_mov_b32 exec_hi, 0
    global_load_lds_dwordx4 v239, s[28:29] offset:3072
    s_mov_b32 exec_hi, -1
    s_add_u32 m0, s35, 69632
    s_add_u32 s28, s6, 29696
    s_addc_u32 s29, s7, 0
    global_load_lds_dwordx4 v239, s[28:29] offset:-3072
    global_load_lds_dwordx4 v239, s[28:29] offset:-2048
    global_load_lds_dwordx4 v239, s[28:29] offset:-1024
    global_load_lds_dwordx4 v239, s[28:29] offset:0
    global_load_lds_dwordx4 v239, s[28:29] offset:1024
    global_load_lds_dwordx4 v239, s[28:29] offset:2048
    s_mov_b32 exec_hi, 0
    global_load_lds_dwordx4 v239, s[28:29] offset:3072
    s_mov_b32 exec_hi, -1
    s_waitcnt vmcnt(7)
    s_barrier
    ds_read_b64_tr_b16 a[180:181], v253 offset:0
    ds_read_b64_tr_b16 a[182:183], v253 offset:3328
    ds_read_b64_tr_b16 a[148:149], v253 offset:8
    ds_read_b64_tr_b16 a[150:151], v253 offset:3336
    ds_read_b64_tr_b16 a[216:217], v253 offset:256
    ds_read_b64_tr_b16 a[218:219], v253 offset:3584
    ds_read_b64_tr_b16 a[160:161], v253 offset:264
    ds_read_b64_tr_b16 a[162:163], v253 offset:3592
    ds_read_b64_tr_b16 a[252:253], v253 offset:512
    ds_read_b64_tr_b16 a[254:255], v253 offset:3840
    ds_read_b64_tr_b16 a[192:193], v253 offset:520
    ds_read_b64_tr_b16 a[194:195], v253 offset:3848
    ds_read_b64_tr_b16 a[152:153], v254 offset:0
    ds_read_b64_tr_b16 a[154:155], v254 offset:3328
    s_add_u32 m0, s35, 82944
    s_add_u32 s28, s6, 56320
    s_addc_u32 s29, s7, 0
    global_load_lds_dwordx4 v239, s[28:29] offset:-3072
    global_load_lds_dwordx4 v239, s[28:29] offset:-2048
    global_load_lds_dwordx4 v239, s[28:29] offset:-1024
    global_load_lds_dwordx4 v239, s[28:29] offset:0
    global_load_lds_dwordx4 v239, s[28:29] offset:1024
    global_load_lds_dwordx4 v239, s[28:29] offset:2048
    s_mov_b32 exec_hi, 0
    global_load_lds_dwordx4 v239, s[28:29] offset:3072
    s_mov_b32 exec_hi, -1
    ds_read_b128 a[0:3], v214 offset:0
    ds_read_b128 a[16:19], v216 offset:0
    ds_read_b128 a[4:7], v214 offset:13312
    ds_read_b128 a[20:23], v216 offset:13312
    ds_read_b128 a[8:11], v215 offset:0
    ds_read_b128 a[24:27], v218 offset:0
    ds_read_b128 a[12:15], v215 offset:13312
    ds_read_b128 a[28:31], v218 offset:13312
    s_waitcnt vmcnt(7)
    s_barrier
    ds_read_b64_tr_b16 a[228:229], v253 offset:13312
    ds_read_b64_tr_b16 a[230:231], v253 offset:16640
    ds_read_b64_tr_b16 a[164:165], v253 offset:13320
    ds_read_b64_tr_b16 a[166:167], v253 offset:16648
    ds_read_b64_tr_b16 a[144:145], v253 offset:13568
    ds_read_b64_tr_b16 a[146:147], v253 offset:16896
    ds_read_b64_tr_b16 a[204:205], v253 offset:13576
    ds_read_b64_tr_b16 a[206:207], v253 offset:16904
    ds_read_b64_tr_b16 a[156:157], v253 offset:13824
    ds_read_b64_tr_b16 a[158:159], v253 offset:17152
    ds_read_b64_tr_b16 a[240:241], v253 offset:13832
    ds_read_b64_tr_b16 a[242:243], v253 offset:17160
    ds_read_b64_tr_b16 a[168:169], v254 offset:13312
    ds_read_b64_tr_b16 a[170:171], v254 offset:16640
    s_waitcnt lgkmcnt(14)
    v_mfma_f32_16x16x32_bf16 v[0:3], a[180:183], a[0:3], v[224:227]
    s_waitcnt lgkmcnt(12)
    ds_read_b128 a[32:35], v214 offset:1024
    s_add_u32 m0, s35, 96256
    v_mfma_f32_16x16x32_bf16 v[0:3], a[228:231], a[16:19], v[0:3]
    s_add_u32 s28, s6, 82944
    ds_read_b128 a[48:51], v216 offset:1024
    s_addc_u32 s29, s7, 0
    v_mfma_f32_16x16x32_bf16 v[4:7], a[180:183], a[4:7], v[224:227]
    global_load_lds_dwordx4 v239, s[28:29] offset:-3072
    ds_read_b128 a[36:39], v214 offset:14336
    v_mfma_f32_16x16x32_bf16 v[4:7], a[228:231], a[20:23], v[4:7]
    ds_read_b128 a[52:55], v216 offset:14336
    v_mfma_f32_16x16x32_bf16 v[8:11], a[180:183], a[8:11], v[224:227]
    ds_read_b128 a[40:43], v215 offset:1024
    v_mfma_f32_16x16x32_bf16 v[8:11], a[228:231], a[24:27], v[8:11]
    global_load_lds_dwordx4 v239, s[28:29] offset:-2048
    ds_read_b128 a[56:59], v218 offset:1024
    v_mfma_f32_16x16x32_bf16 v[12:15], a[180:183], a[12:15], v[224:227]
    ds_read_b128 a[44:47], v215 offset:14336
    v_mfma_f32_16x16x32_bf16 v[12:15], a[228:231], a[28:31], v[12:15]
    ds_read_b128 a[60:63], v218 offset:14336
    v_mfma_f32_16x16x32_bf16 v[16:19], a[148:151], a[0:3], v[224:227]
    s_waitcnt lgkmcnt(14)
    global_load_lds_dwordx4 v239, s[28:29] offset:-1024
    ds_read_b128 v[108:111], v236 offset:0
    v_mfma_f32_16x16x32_bf16 v[16:19], a[164:167], a[16:19], v[16:19]
    ds_read_b128 v[116:119], v236 offset:13312
    v_mfma_f32_16x16x32_bf16 v[20:23], a[148:151], a[4:7], v[224:227]
    s_waitcnt vmcnt(3) lgkmcnt(10)
    s_barrier
    v_mfma_f32_16x16x32_bf16 v[20:23], a[164:167], a[20:23], v[20:23]
    global_load_lds_dwordx4 v239, s[28:29] offset:0
    ds_read_b64_tr_b16 a[172:173], v253 offset:26624
    v_mfma_f32_16x16x32_bf16 v[24:27], a[148:151], a[8:11], v[224:227]
    ds_read_b64_tr_b16 a[174:175], v253 offset:29952
    v_mfma_f32_16x16x32_bf16 v[24:27], a[164:167], a[24:27], v[24:27]
    s_waitcnt lgkmcnt(3)
    ds_read_b64_tr_b16 a[220:221], v253 offset:26632
    v_lshlrev_b32 v104, 16, v108
    v_mfma_f32_16x16x32_bf16 v[28:31], a[148:151], a[12:15], v[224:227]
    global_load_lds_dwordx4 v239, s[28:29] offset:1024
    ds_read_b64_tr_b16 a[222:223], v253 offset:29960
    v_mfma_f32_16x16x32_bf16 v[28:31], a[164:167], a[28:31], v[28:31]
    ds_read_b64_tr_b16 a[188:189], v253 offset:26880
    v_and_b32 v105, 0xffff0000, v108
    v_mfma_f32_16x16x32_bf16 v[32:35], a[216:219], a[0:3], v[224:227]
    ds_read_b64_tr_b16 a[190:191], v253 offset:30208
    v_lshlrev_b32 v106, 16, v109
    v_mfma_f32_16x16x32_bf16 v[32:35], a[144:147], a[16:19], v[32:35]
    global_load_lds_dwordx4 v239, s[28:29] offset:2048
    ds_read_b64_tr_b16 a[236:237], v253 offset:26888
    v_mfma_f32_16x16x32_bf16 v[36:39], a[216:219], a[4:7], v[224:227]
    ds_read_b64_tr_b16 a[238:239], v253 offset:30216
    v_and_b32 v107, 0xffff0000, v109
    v_mfma_f32_16x16x32_bf16 v[36:39], a[144:147], a[20:23], v[36:39]
    ds_read_b64_tr_b16 a[208:209], v253 offset:27136
    v_lshlrev_b32 v108, 16, v110
    v_mfma_f32_16x16x32_bf16 v[40:43], a[216:219], a[8:11], v[224:227]
    s_mov_b32 exec_hi, 0
    global_load_lds_dwordx4 v239, s[28:29] offset:3072
    s_mov_b32 exec_hi, -1
    v_mfma_f32_16x16x32_bf16 v[40:43], a[144:147], a[24:27], v[40:43]
    s_add_u32 m0, s35, 56320
    ds_read_b64_tr_b16 a[210:211], v253 offset:30464
    v_and_b32 v109, 0xffff0000, v110
    v_mfma_f32_16x16x32_bf16 v[44:47], a[216:219], a[12:15], v[224:227]
    s_add_u32 s28, s6, 109568
    ds_read_b64_tr_b16 a[176:177], v253 offset:27144
    v_lshlrev_b32 v110, 16, v111
    v_mfma_f32_16x16x32_bf16 v[44:47], a[144:147], a[28:31], v[44:47]
    s_addc_u32 s29, s7, 0
    ds_read_b64_tr_b16 a[178:179], v253 offset:30472
    v_and_b32 v111, 0xffff0000, v111
    v_mfma_f32_16x16x32_bf16 v[48:51], a[160:163], a[0:3], v[224:227]
    global_load_lds_dwordx4 v239, s[28:29] offset:-3072
    ds_read_b64_tr_b16 a[224:225], v254 offset:26624
    v_mfma_f32_16x16x32_bf16 v[48:51], a[204:207], a[16:19], v[48:51]
    s_waitcnt lgkmcnt(13)
    ds_read_b64_tr_b16 a[226:227], v254 offset:29952
    v_lshlrev_b32 v112, 16, v116
    v_mfma_f32_16x16x32_bf16 v[52:55], a[160:163], a[4:7], v[224:227]
    ds_read_b128 v[124:127], v237 offset:0
    v_and_b32 v113, 0xffff0000, v116
    v_mfma_f32_16x16x32_bf16 v[52:55], a[204:207], a[20:23], v[52:55]
    global_load_lds_dwordx4 v239, s[28:29] offset:-2048
    ds_read_b128 v[132:135], v237 offset:13312
    v_mfma_f32_16x16x32_bf16 v[56:59], a[160:163], a[8:11], v[224:227]
    ds_read_b128 v[140:143], v236 offset:2048
    v_lshlrev_b32 v114, 16, v117
    v_mfma_f32_16x16x32_bf16 v[56:59], a[204:207], a[24:27], v[56:59]
    ds_read_b128 v[148:151], v236 offset:15360
    v_and_b32 v115, 0xffff0000, v117
    v_mfma_f32_16x16x32_bf16 v[60:63], a[160:163], a[12:15], v[224:227]
    global_load_lds_dwordx4 v239, s[28:29] offset:-1024
    ds_read_b128 v[156:159], v237 offset:2048
    v_mfma_f32_16x16x32_bf16 v[60:63], a[204:207], a[28:31], v[60:63]
    ds_read_b128 v[164:167], v237 offset:15360
    v_lshlrev_b32 v116, 16, v118
    v_mfma_f32_16x16x32_bf16 v[64:67], a[252:255], a[0:3], v[224:227]
    ds_read_b128 v[172:175], v236 offset:4096
    v_and_b32 v117, 0xffff0000, v118
    v_mfma_f32_16x16x32_bf16 v[64:67], a[156:159], a[16:19], v[64:67]
    global_load_lds_dwordx4 v239, s[28:29] offset:0
    ds_read_b128 v[180:183], v236 offset:17408
    v_mfma_f32_16x16x32_bf16 v[68:71], a[252:255], a[4:7], v[224:227]
    ds_read_b128 v[188:191], v237 offset:4096
    v_lshlrev_b32 v118, 16, v119
    v_mfma_f32_16x16x32_bf16 v[68:71], a[156:159], a[20:23], v[68:71]
    ds_read_b128 v[196:199], v237 offset:17408
    v_and_b32 v119, 0xffff0000, v119
    v_mfma_f32_16x16x32_bf16 v[72:75], a[252:255], a[8:11], v[224:227]
    s_waitcnt vmcnt(4) lgkmcnt(10)
    s_barrier
    v_mfma_f32_16x16x32_bf16 v[72:75], a[156:159], a[24:27], v[72:75]
    global_load_lds_dwordx4 v239, s[28:29] offset:1024
    ds_read_b64_tr_b16 a[196:197], v253 offset:39936
    v_mfma_f32_16x16x32_bf16 v[76:79], a[252:255], a[12:15], v[224:227]
    s_waitcnt lgkmcnt(10)
    ds_read_b64_tr_b16 a[198:199], v253 offset:43264
    v_lshlrev_b32 v120, 16, v124
    v_mfma_f32_16x16x32_bf16 v[76:79], a[156:159], a[28:31], v[76:79]
    ds_read_b64_tr_b16 a[244:245], v253 offset:39944
    v_and_b32 v121, 0xffff0000, v124
    v_mfma_f32_16x16x32_bf16 v[80:83], a[192:195], a[0:3], v[224:227]
    global_load_lds_dwordx4 v239, s[28:29] offset:2048
    ds_read_b64_tr_b16 a[246:247], v253 offset:43272
    v_mfma_f32_16x16x32_bf16 v[80:83], a[240:243], a[16:19], v[80:83]
    ds_read_b64_tr_b16 a[212:213], v253 offset:40192
    v_lshlrev_b32 v122, 16, v125
    v_mfma_f32_16x16x32_bf16 v[84:87], a[192:195], a[4:7], v[224:227]
    ds_read_b64_tr_b16 a[214:215], v253 offset:43520
    v_and_b32 v123, 0xffff0000, v125
    v_mfma_f32_16x16x32_bf16 v[84:87], a[240:243], a[20:23], v[84:87]
    s_mov_b32 exec_hi, 0
    global_load_lds_dwordx4 v239, s[28:29] offset:3072
    s_mov_b32 exec_hi, -1
    v_mfma_f32_16x16x32_bf16 v[88:91], a[192:195], a[8:11], v[224:227]
    s_add_u32 m0, s35, 69632
    ds_read_b64_tr_b16 a[184:185], v253 offset:40200
    v_lshlrev_b32 v124, 16, v126
    v_mfma_f32_16x16x32_bf16 v[88:91], a[240:243], a[24:27], v[88:91]
    s_add_u32 s28, s6, 136192
    ds_read_b64_tr_b16 a[186:187], v253 offset:43528
    v_and_b32 v125, 0xffff0000, v126
    v_mfma_f32_16x16x32_bf16 v[92:95], a[192:195], a[12:15], v[224:227]
    s_addc_u32 s29, s7, 0
    ds_read_b64_tr_b16 a[232:233], v253 offset:40448
    v_lshlrev_b32 v126, 16, v127
    v_mfma_f32_16x16x32_bf16 v[92:95], a[240:243], a[28:31], v[92:95]
    global_load_lds_dwordx4 v239, s[28:29] offset:-3072
    ds_read_b64_tr_b16 a[234:235], v253 offset:43776
    v_mfma_f32_16x16x32_bf16 v[96:99], a[152:155], a[0:3], v[224:227]
    ds_read_b64_tr_b16 a[200:201], v253 offset:40456
    v_and_b32 v127, 0xffff0000, v127
    v_mfma_f32_16x16x32_bf16 v[96:99], a[168:171], a[16:19], v[96:99]
    s_waitcnt lgkmcnt(14)
    ds_read_b64_tr_b16 a[202:203], v253 offset:43784
    v_lshlrev_b32 v128, 16, v132
    v_mfma_f32_16x16x32_bf16 v[100:103], a[152:155], a[4:7], v[224:227]
    global_load_lds_dwordx4 v239, s[28:29] offset:-2048
    ds_read_b64_tr_b16 a[248:249], v254 offset:39936
    v_mfma_f32_16x16x32_bf16 v[100:103], a[168:171], a[20:23], v[100:103]
    ds_read_b64_tr_b16 a[250:251], v254 offset:43264
    v_and_b32 v129, 0xffff0000, v132
    v_mfma_f32_16x16x32_bf16 v[0:3], a[172:175], a[32:35], v[0:3]
    s_waitcnt lgkmcnt(12)
    ds_read_b128 a[0:3], v214 offset:2048
    v_lshlrev_b32 v130, 16, v133
    v_mfma_f32_16x16x32_bf16 v[0:3], a[196:199], a[48:51], v[0:3]
    global_load_lds_dwordx4 v239, s[28:29] offset:-1024
    ds_read_b128 a[16:19], v216 offset:2048
    v_mfma_f32_16x16x32_bf16 v[4:7], a[172:175], a[36:39], v[4:7]
    ds_read_b128 a[4:7], v214 offset:15360
    v_and_b32 v131, 0xffff0000, v133
    v_mfma_f32_16x16x32_bf16 v[4:7], a[196:199], a[52:55], v[4:7]
    ds_read_b128 a[20:23], v216 offset:15360
    v_lshlrev_b32 v132, 16, v134
    v_mfma_f32_16x16x32_bf16 v[8:11], a[172:175], a[40:43], v[8:11]
    global_load_lds_dwordx4 v239, s[28:29] offset:0
    ds_read_b128 a[8:11], v215 offset:2048
    v_mfma_f32_16x16x32_bf16 v[8:11], a[196:199], a[56:59], v[8:11]
    ds_read_b128 a[24:27], v218 offset:2048
    v_and_b32 v133, 0xffff0000, v134
    v_mfma_f32_16x16x32_bf16 v[12:15], a[172:175], a[44:47], v[12:15]
    ds_read_b128 a[12:15], v215 offset:15360
    v_lshlrev_b32 v134, 16, v135
    v_mfma_f32_16x16x32_bf16 v[12:15], a[196:199], a[60:63], v[12:15]
    global_load_lds_dwordx4 v239, s[28:29] offset:1024
    ds_read_b128 a[28:31], v218 offset:15360
    v_mfma_f32_16x16x32_bf16 v[16:19], a[220:223], a[32:35], v[16:19]
    s_waitcnt lgkmcnt(14)
    ds_read_b64 v[202:203], v238 offset:6144
    v_and_b32 v135, 0xffff0000, v135
    v_mfma_f32_16x16x32_bf16 v[16:19], a[244:247], a[48:51], v[16:19]
    ds_read_b64 v[206:207], v238 offset:19456
    v_lshlrev_b32 v136, 16, v140
    v_mfma_f32_16x16x32_bf16 v[20:23], a[220:223], a[36:39], v[20:23]
    global_load_lds_dwordx4 v239, s[28:29] offset:2048
    v_and_b32 v137, 0xffff0000, v140
    v_mfma_f32_16x16x32_bf16 v[20:23], a[244:247], a[52:55], v[20:23]
    v_lshlrev_b32 v138, 16, v141
    v_and_b32 v139, 0xffff0000, v141
    v_mfma_f32_16x16x32_bf16 v[24:27], a[220:223], a[40:43], v[24:27]
    s_waitcnt vmcnt(6) lgkmcnt(10)
    s_barrier
    v_mfma_f32_16x16x32_bf16 v[24:27], a[244:247], a[56:59], v[24:27]
    s_mov_b32 exec_hi, 0
    global_load_lds_dwordx4 v239, s[28:29] offset:3072
    s_mov_b32 exec_hi, -1
    v_mfma_f32_16x16x32_bf16 v[28:31], a[220:223], a[44:47], v[28:31]
    s_add_u32 m0, s35, 82944
    ds_read_b64_tr_b16 a[180:181], v253 offset:0
    v_lshlrev_b32 v140, 16, v142
    v_mfma_f32_16x16x32_bf16 v[28:31], a[244:247], a[60:63], v[28:31]
    s_add_u32 s28, s6, 162816
    ds_read_b64_tr_b16 a[182:183], v253 offset:3328
    v_and_b32 v141, 0xffff0000, v142
    v_mfma_f32_16x16x32_bf16 v[32:35], a[188:191], a[32:35], v[32:35]
    s_addc_u32 s29, s7, 0
    ds_read_b64_tr_b16 a[228:229], v253 offset:8
    v_lshlrev_b32 v142, 16, v143
    v_mfma_f32_16x16x32_bf16 v[32:35], a[212:215], a[48:51], v[32:35]
    global_load_lds_dwordx4 v239, s[28:29] offset:-3072
    ds_read_b64_tr_b16 a[230:231], v253 offset:3336
    v_mfma_f32_16x16x32_bf16 v[36:39], a[188:191], a[36:39], v[36:39]
    ds_read_b64_tr_b16 a[148:149], v253 offset:256
    v_and_b32 v143, 0xffff0000, v143
    v_mfma_f32_16x16x32_bf16 v[36:39], a[212:215], a[52:55], v[36:39]
    ds_read_b64_tr_b16 a[150:151], v253 offset:3584
    v_lshlrev_b32 v144, 16, v148
    v_mfma_f32_16x16x32_bf16 v[40:43], a[188:191], a[40:43], v[40:43]
    global_load_lds_dwordx4 v239, s[28:29] offset:-2048
    ds_read_b64_tr_b16 a[164:165], v253 offset:264
    v_mfma_f32_16x16x32_bf16 v[40:43], a[212:215], a[56:59], v[40:43]
    ds_read_b64_tr_b16 a[166:167], v253 offset:3592
    v_and_b32 v145, 0xffff0000, v148
    v_mfma_f32_16x16x32_bf16 v[44:47], a[188:191], a[44:47], v[44:47]
    ds_read_b64_tr_b16 a[216:217], v253 offset:512
    v_lshlrev_b32 v146, 16, v149
    v_mfma_f32_16x16x32_bf16 v[44:47], a[212:215], a[60:63], v[44:47]
    global_load_lds_dwordx4 v239, s[28:29] offset:-1024
    ds_read_b64_tr_b16 a[218:219], v253 offset:3840
    v_mfma_f32_16x16x32_bf16 v[48:51], a[236:239], a[32:35], v[48:51]
    ds_read_b64_tr_b16 a[144:145], v253 offset:520
    v_and_b32 v147, 0xffff0000, v149
    v_mfma_f32_16x16x32_bf16 v[48:51], a[184:187], a[48:51], v[48:51]
    ds_read_b64_tr_b16 a[146:147], v253 offset:3848
    v_lshlrev_b32 v148, 16, v150
    v_mfma_f32_16x16x32_bf16 v[52:55], a[236:239], a[36:39], v[52:55]
    global_load_lds_dwordx4 v239, s[28:29] offset:0
    ds_read_b64_tr_b16 a[160:161], v254 offset:0
    v_mfma_f32_16x16x32_bf16 v[52:55], a[184:187], a[52:55], v[52:55]
    ds_read_b64_tr_b16 a[162:163], v254 offset:3328
    v_and_b32 v149, 0xffff0000, v150
    v_mfma_f32_16x16x32_bf16 v[56:59], a[236:239], a[40:43], v[56:59]
    v_lshlrev_b32 v150, 16, v151
    v_and_b32 v151, 0xffff0000, v151
    v_mfma_f32_16x16x32_bf16 v[56:59], a[184:187], a[56:59], v[56:59]
    global_load_lds_dwordx4 v239, s[28:29] offset:1024
    v_lshlrev_b32 v152, 16, v156
    v_mfma_f32_16x16x32_bf16 v[60:63], a[236:239], a[44:47], v[60:63]
    v_and_b32 v153, 0xffff0000, v156
    v_lshlrev_b32 v154, 16, v157
    v_mfma_f32_16x16x32_bf16 v[60:63], a[184:187], a[60:63], v[60:63]
    v_and_b32 v155, 0xffff0000, v157
    v_lshlrev_b32 v156, 16, v158
    v_mfma_f32_16x16x32_bf16 v[64:67], a[208:211], a[32:35], v[64:67]
    global_load_lds_dwordx4 v239, s[28:29] offset:2048
    v_and_b32 v157, 0xffff0000, v158
    v_mfma_f32_16x16x32_bf16 v[64:67], a[232:235], a[48:51], v[64:67]
    v_lshlrev_b32 v158, 16, v159
    v_and_b32 v159, 0xffff0000, v159
    v_mfma_f32_16x16x32_bf16 v[68:71], a[208:211], a[36:39], v[68:71]
    v_lshlrev_b32 v160, 16, v164
    v_and_b32 v161, 0xffff0000, v164
    v_mfma_f32_16x16x32_bf16 v[68:71], a[232:235], a[52:55], v[68:71]
    s_mov_b32 exec_hi, 0
    global_load_lds_dwordx4 v239, s[28:29] offset:3072
    s_mov_b32 exec_hi, -1
    v_mfma_f32_16x16x32_bf16 v[72:75], a[208:211], a[40:43], v[72:75]
    s_waitcnt vmcnt(7) lgkmcnt(0)
    s_barrier
    v_mfma_f32_16x16x32_bf16 v[72:75], a[232:235], a[56:59], v[72:75]
    s_add_u32 m0, s35, 96256
    ds_read_b64_tr_b16 a[204:205], v253 offset:13312
    v_lshlrev_b32 v162, 16, v165
    v_mfma_f32_16x16x32_bf16 v[76:79], a[208:211], a[44:47], v[76:79]
    s_add_u32 s28, s6, 189440
    ds_read_b64_tr_b16 a[206:207], v253 offset:16640
    v_and_b32 v163, 0xffff0000, v165
    v_mfma_f32_16x16x32_bf16 v[76:79], a[232:235], a[60:63], v[76:79]
    s_addc_u32 s29, s7, 0
    ds_read_b64_tr_b16 a[252:253], v253 offset:13320
    v_lshlrev_b32 v164, 16, v166
    v_mfma_f32_16x16x32_bf16 v[80:83], a[176:179], a[32:35], v[80:83]
    global_load_lds_dwordx4 v239, s[28:29] offset:-3072
    ds_read_b64_tr_b16 a[254:255], v253 offset:16648
    v_mfma_f32_16x16x32_bf16 v[80:83], a[200:203], a[48:51], v[80:83]
    ds_read_b64_tr_b16 a[156:157], v253 offset:13568
    v_and_b32 v165, 0xffff0000, v166
    v_mfma_f32_16x16x32_bf16 v[84:87], a[176:179], a[36:39], v[84:87]
    ds_read_b64_tr_b16 a[158:159], v253 offset:16896
    v_lshlrev_b32 v166, 16, v167
    v_mfma_f32_16x16x32_bf16 v[84:87], a[200:203], a[52:55], v[84:87]
    global_load_lds_dwordx4 v239, s[28:29] offset:-2048
    ds_read_b64_tr_b16 a[192:193], v253 offset:13576
    v_mfma_f32_16x16x32_bf16 v[88:91], a[176:179], a[40:43], v[88:91]
    ds_read_b64_tr_b16 a[194:195], v253 offset:16904
    v_and_b32 v167, 0xffff0000, v167
    v_mfma_f32_16x16x32_bf16 v[88:91], a[200:203], a[56:59], v[88:91]
    ds_read_b64_tr_b16 a[240:241], v253 offset:13824
    v_lshlrev_b32 v168, 16, v172
    v_mfma_f32_16x16x32_bf16 v[92:95], a[176:179], a[44:47], v[92:95]
    global_load_lds_dwordx4 v239, s[28:29] offset:-1024
    ds_read_b64_tr_b16 a[242:243], v253 offset:17152
    v_mfma_f32_16x16x32_bf16 v[92:95], a[200:203], a[60:63], v[92:95]
    ds_read_b64_tr_b16 a[152:153], v253 offset:13832
    v_and_b32 v169, 0xffff0000, v172
    v_mfma_f32_16x16x32_bf16 v[96:99], a[224:227], a[32:35], v[96:99]
    ds_read_b64_tr_b16 a[154:155], v253 offset:17160
    v_lshlrev_b32 v170, 16, v173
    v_mfma_f32_16x16x32_bf16 v[96:99], a[248:251], a[48:51], v[96:99]
    global_load_lds_dwordx4 v239, s[28:29] offset:0
    ds_read_b64_tr_b16 a[168:169], v254 offset:13312
    v_mfma_f32_16x16x32_bf16 v[100:103], a[224:227], a[36:39], v[100:103]
    ds_read_b64_tr_b16 a[170:171], v254 offset:16640
    v_and_b32 v171, 0xffff0000, v173
    v_mfma_f32_16x16x32_bf16 v[100:103], a[248:251], a[52:55], v[100:103]
    ds_read_b128 a[32:35], v214 offset:3072
    v_lshlrev_b32 v172, 16, v174
    v_mfma_f32_16x16x32_bf16 v[0:3], a[180:183], a[0:3], v[0:3]
    s_waitcnt lgkmcnt(13)
    global_load_lds_dwordx4 v239, s[28:29] offset:1024
    ds_read_b128 a[48:51], v216 offset:3072
    v_mfma_f32_16x16x32_bf16 v[0:3], a[204:207], a[16:19], v[0:3]
    ds_read_b128 a[36:39], v214 offset:16384
    v_and_b32 v173, 0xffff0000, v174
    v_mfma_f32_16x16x32_bf16 v[4:7], a[180:183], a[4:7], v[4:7]
    ds_read_b128 a[52:55], v216 offset:16384
    v_lshlrev_b32 v174, 16, v175
    v_mfma_f32_16x16x32_bf16 v[4:7], a[204:207], a[20:23], v[4:7]
    global_load_lds_dwordx4 v239, s[28:29] offset:2048
    ds_read_b128 a[40:43], v215 offset:3072
    v_mfma_f32_16x16x32_bf16 v[8:11], a[180:183], a[8:11], v[8:11]
    ds_read_b128 a[56:59], v218 offset:3072
    v_and_b32 v175, 0xffff0000, v175
    v_mfma_f32_16x16x32_bf16 v[8:11], a[204:207], a[24:27], v[8:11]
    ds_read_b128 a[44:47], v215 offset:16384
    v_lshlrev_b32 v176, 16, v180
    v_mfma_f32_16x16x32_bf16 v[12:15], a[180:183], a[12:15], v[12:15]
    s_mov_b32 exec_hi, 0
    global_load_lds_dwordx4 v239, s[28:29] offset:3072
    s_mov_b32 exec_hi, -1
    v_mfma_f32_16x16x32_bf16 v[12:15], a[204:207], a[28:31], v[12:15]
    s_add_u32 m0, s35, 56320
    ds_read_b128 a[60:63], v218 offset:16384
    v_and_b32 v177, 0xffff0000, v180
    v_mfma_f32_16x16x32_bf16 v[16:19], a[228:231], a[0:3], v[16:19]
    s_waitcnt vmcnt(7) lgkmcnt(8)
    s_barrier
    v_mfma_f32_16x16x32_bf16 v[16:19], a[252:255], a[16:19], v[16:19]
    s_add_u32 s28, s6, 216064
    ds_read_b64_tr_b16 a[172:173], v253 offset:26624
    v_lshlrev_b32 v178, 16, v181
    v_mfma_f32_16x16x32_bf16 v[20:23], a[228:231], a[4:7], v[20:23]
    s_addc_u32 s29, s7, 0
    ds_read_b64_tr_b16 a[174:175], v253 offset:29952
    v_and_b32 v179, 0xffff0000, v181
    v_mfma_f32_16x16x32_bf16 v[20:23], a[252:255], a[20:23], v[20:23]
    global_load_lds_dwordx4 v239, s[28:29] offset:-3072
    ds_read_b64_tr_b16 a[196:197], v253 offset:26632
    v_mfma_f32_16x16x32_bf16 v[24:27], a[228:231], a[8:11], v[24:27]
    ds_read_b64_tr_b16 a[198:199], v253 offset:29960
    v_lshlrev_b32 v180, 16, v182
    v_mfma_f32_16x16x32_bf16 v[24:27], a[252:255], a[24:27], v[24:27]
    ds_read_b64_tr_b16 a[220:221], v253 offset:26880
    v_and_b32 v181, 0xffff0000, v182
    v_mfma_f32_16x16x32_bf16 v[28:31], a[228:231], a[12:15], v[28:31]
    global_load_lds_dwordx4 v239, s[28:29] offset:-2048
    ds_read_b64_tr_b16 a[222:223], v253 offset:30208
    v_mfma_f32_16x16x32_bf16 v[28:31], a[252:255], a[28:31], v[28:31]
    ds_read_b64_tr_b16 a[244:245], v253 offset:26888
    v_lshlrev_b32 v182, 16, v183
    v_mfma_f32_16x16x32_bf16 v[32:35], a[148:151], a[0:3], v[32:35]
    ds_read_b64_tr_b16 a[246:247], v253 offset:30216
    v_and_b32 v183, 0xffff0000, v183
    v_mfma_f32_16x16x32_bf16 v[32:35], a[156:159], a[16:19], v[32:35]
    global_load_lds_dwordx4 v239, s[28:29] offset:-1024
    ds_read_b64_tr_b16 a[188:189], v253 offset:27136
    v_mfma_f32_16x16x32_bf16 v[36:39], a[148:151], a[4:7], v[36:39]
    ds_read_b64_tr_b16 a[190:191], v253 offset:30464
    v_lshlrev_b32 v184, 16, v188
    v_mfma_f32_16x16x32_bf16 v[36:39], a[156:159], a[20:23], v[36:39]
    ds_read_b64_tr_b16 a[212:213], v253 offset:27144
    v_and_b32 v185, 0xffff0000, v188
    v_mfma_f32_16x16x32_bf16 v[40:43], a[148:151], a[8:11], v[40:43]
    global_load_lds_dwordx4 v239, s[28:29] offset:0
    ds_read_b64_tr_b16 a[214:215], v253 offset:30472
    v_mfma_f32_16x16x32_bf16 v[40:43], a[156:159], a[24:27], v[40:43]
    ds_read_b64_tr_b16 a[236:237], v254 offset:26624
    v_lshlrev_b32 v186, 16, v189
    v_mfma_f32_16x16x32_bf16 v[44:47], a[148:151], a[12:15], v[44:47]
    ds_read_b64_tr_b16 a[238:239], v254 offset:29952
    v_and_b32 v187, 0xffff0000, v189
    v_mfma_f32_16x16x32_bf16 v[44:47], a[156:159], a[28:31], v[44:47]
    global_load_lds_dwordx4 v239, s[28:29] offset:1024
    ds_read_b128 a[64:67], v214 offset:4096
    v_mfma_f32_16x16x32_bf16 v[48:51], a[164:167], a[0:3], v[48:51]
    ds_read_b128 a[80:83], v216 offset:4096
    v_lshlrev_b32 v188, 16, v190
    v_mfma_f32_16x16x32_bf16 v[48:51], a[192:195], a[16:19], v[48:51]
    ds_read_b128 a[68:71], v214 offset:17408
    v_and_b32 v189, 0xffff0000, v190
    v_mfma_f32_16x16x32_bf16 v[52:55], a[164:167], a[4:7], v[52:55]
    global_load_lds_dwordx4 v239, s[28:29] offset:2048
    ds_read_b128 a[84:87], v216 offset:17408
    v_mfma_f32_16x16x32_bf16 v[52:55], a[192:195], a[20:23], v[52:55]
    ds_read_b128 a[72:75], v215 offset:4096
    v_lshlrev_b32 v190, 16, v191
    v_mfma_f32_16x16x32_bf16 v[56:59], a[164:167], a[8:11], v[56:59]
    ds_read_b128 a[88:91], v218 offset:4096
    v_and_b32 v191, 0xffff0000, v191
    v_mfma_f32_16x16x32_bf16 v[56:59], a[192:195], a[24:27], v[56:59]
    s_mov_b32 exec_hi, 0
    global_load_lds_dwordx4 v239, s[28:29] offset:3072
    s_mov_b32 exec_hi, -1
    v_mfma_f32_16x16x32_bf16 v[60:63], a[164:167], a[12:15], v[60:63]
    s_add_u32 m0, s35, 69632
    ds_read_b128 a[76:79], v215 offset:17408
    v_lshlrev_b32 v192, 16, v196
    v_mfma_f32_16x16x32_bf16 v[60:63], a[192:195], a[28:31], v[60:63]
    s_add_u32 s28, s6, 242688
    ds_read_b128 a[92:95], v218 offset:17408
    v_and_b32 v193, 0xffff0000, v196
    v_mfma_f32_16x16x32_bf16 v[64:67], a[216:219], a[0:3], v[64:67]
    s_addc_u32 s29, s7, 0
    ds_read_b128 a[96:99], v214 offset:5120
    v_lshlrev_b32 v194, 16, v197
    v_mfma_f32_16x16x32_bf16 v[64:67], a[240:243], a[16:19], v[64:67]
    global_load_lds_dwordx4 v239, s[28:29] offset:-3072
    ds_read_b128 a[112:115], v216 offset:5120
    v_mfma_f32_16x16x32_bf16 v[68:71], a[216:219], a[4:7], v[68:71]
    s_waitcnt vmcnt(8) lgkmcnt(10)
    s_barrier
    v_mfma_f32_16x16x32_bf16 v[68:71], a[240:243], a[20:23], v[68:71]
    ds_read_b64_tr_b16 a[184:185], v253 offset:39936
    v_and_b32 v195, 0xffff0000, v197
    v_mfma_f32_16x16x32_bf16 v[72:75], a[216:219], a[8:11], v[72:75]
    global_load_lds_dwordx4 v239, s[28:29] offset:-2048
    ds_read_b64_tr_b16 a[186:187], v253 offset:43264
    v_mfma_f32_16x16x32_bf16 v[72:75], a[240:243], a[24:27], v[72:75]
    ds_read_b64_tr_b16 a[208:209], v253 offset:39944
    v_lshlrev_b32 v196, 16, v198
    v_mfma_f32_16x16x32_bf16 v[76:79], a[216:219], a[12:15], v[76:79]
    ds_read_b64_tr_b16 a[210:211], v253 offset:43272
    v_and_b32 v197, 0xffff0000, v198
    v_mfma_f32_16x16x32_bf16 v[76:79], a[240:243], a[28:31], v[76:79]
    global_load_lds_dwordx4 v239, s[28:29] offset:-1024
    ds_read_b64_tr_b16 a[232:233], v253 offset:40192
    v_mfma_f32_16x16x32_bf16 v[80:83], a[144:147], a[0:3], v[80:83]
    ds_read_b64_tr_b16 a[234:235], v253 offset:43520
    v_lshlrev_b32 v198, 16, v199
    v_mfma_f32_16x16x32_bf16 v[80:83], a[152:155], a[16:19], v[80:83]
    ds_read_b64_tr_b16 a[176:177], v253 offset:40200
    v_and_b32 v199, 0xffff0000, v199
    v_mfma_f32_16x16x32_bf16 v[84:87], a[144:147], a[4:7], v[84:87]
    global_load_lds_dwordx4 v239, s[28:29] offset:0
    ds_read_b64_tr_b16 a[178:179], v253 offset:43528
    v_mfma_f32_16x16x32_bf16 v[84:87], a[152:155], a[20:23], v[84:87]
    ds_read_b64_tr_b16 a[200:201], v253 offset:40448
    v_lshlrev_b32 v200, 16, v202
    v_mfma_f32_16x16x32_bf16 v[88:91], a[144:147], a[8:11], v[88:91]
    ds_read_b64_tr_b16 a[202:203], v253 offset:43776
    v_and_b32 v201, 0xffff0000, v202
    v_mfma_f32_16x16x32_bf16 v[88:91], a[152:155], a[24:27], v[88:91]
    global_load_lds_dwordx4 v239, s[28:29] offset:1024
    ds_read_b64_tr_b16 a[224:225], v253 offset:40456
    v_mfma_f32_16x16x32_bf16 v[92:95], a[144:147], a[12:15], v[92:95]
    ds_read_b64_tr_b16 a[226:227], v253 offset:43784
    v_lshlrev_b32 v202, 16, v203
    v_mfma_f32_16x16x32_bf16 v[92:95], a[152:155], a[28:31], v[92:95]
    ds_read_b64_tr_b16 a[248:249], v254 offset:39936
    v_and_b32 v203, 0xffff0000, v203
    v_mfma_f32_16x16x32_bf16 v[96:99], a[160:163], a[0:3], v[96:99]
    global_load_lds_dwordx4 v239, s[28:29] offset:2048
    ds_read_b64_tr_b16 a[250:251], v254 offset:43264
    v_mfma_f32_16x16x32_bf16 v[96:99], a[168:171], a[16:19], v[96:99]
    ds_read_b128 a[128:131], v214 offset:6144
    v_lshlrev_b32 v204, 16, v206
    v_mfma_f32_16x16x32_bf16 v[100:103], a[160:163], a[4:7], v[100:103]
    ds_read_b128 a[100:103], v214 offset:18432
    v_and_b32 v205, 0xffff0000, v206
    v_mfma_f32_16x16x32_bf16 v[100:103], a[168:171], a[20:23], v[100:103]
    s_mov_b32 exec_hi, 0
    global_load_lds_dwordx4 v239, s[28:29] offset:3072
    s_mov_b32 exec_hi, -1
    v_mfma_f32_16x16x32_bf16 v[0:3], a[172:175], a[32:35], v[0:3]
    s_waitcnt lgkmcnt(14)
    ds_read_b128 a[116:119], v216 offset:18432
    v_lshlrev_b32 v206, 16, v207
    v_mfma_f32_16x16x32_bf16 v[0:3], a[184:187], a[48:51], v[0:3]
    s_add_u32 m0, s35, 82944
    ds_read_b128 a[132:135], v214 offset:19456
    v_and_b32 v207, 0xffff0000, v207
    v_mfma_f32_16x16x32_bf16 v[4:7], a[172:175], a[36:39], v[4:7]
    s_add_u32 s28, s6, 269312
    ds_read_b128 a[104:107], v215 offset:5120
    v_lshlrev_b32 v224, 16, v208
    v_mfma_f32_16x16x32_bf16 v[4:7], a[184:187], a[52:55], v[4:7]
    s_addc_u32 s29, s7, 0
    ds_read_b128 a[120:123], v218 offset:5120
    v_and_b32 v225, 0xffff0000, v208
    v_mfma_f32_16x16x32_bf16 v[8:11], a[172:175], a[40:43], v[8:11]
    global_load_lds_dwordx4 v239, s[28:29] offset:-3072
    ds_read_b128 a[136:139], v215 offset:6144
    v_mfma_f32_16x16x32_bf16 v[8:11], a[184:187], a[56:59], v[8:11]
    ds_read_b128 a[108:111], v215 offset:18432
    v_add_f32 v224, 0xc11a0000, v224
    v_mfma_f32_16x16x32_bf16 v[12:15], a[172:175], a[44:47], v[12:15]
    ds_read_b128 a[124:127], v218 offset:18432
    v_add_f32 v225, 0xc11a0000, v225
    v_mfma_f32_16x16x32_bf16 v[12:15], a[184:187], a[60:63], v[12:15]
    global_load_lds_dwordx4 v239, s[28:29] offset:-2048
    ds_read_b128 a[140:143], v215 offset:19456
    v_mfma_f32_16x16x32_bf16 v[16:19], a[196:199], a[32:35], v[16:19]
    s_waitcnt vmcnt(9) lgkmcnt(10)
    s_barrier
    v_mfma_f32_16x16x32_bf16 v[16:19], a[208:211], a[48:51], v[16:19]
    ds_read_b64_tr_b16 a[180:181], v253 offset:0
    v_lshlrev_b32 v226, 16, v209
    v_mfma_f32_16x16x32_bf16 v[20:23], a[196:199], a[36:39], v[20:23]
    global_load_lds_dwordx4 v239, s[28:29] offset:-1024
    ds_read_b64_tr_b16 a[182:183], v253 offset:3328
    v_mfma_f32_16x16x32_bf16 v[20:23], a[208:211], a[52:55], v[20:23]
    ds_read_b64_tr_b16 a[204:205], v253 offset:8
    v_and_b32 v227, 0xffff0000, v209
    v_mfma_f32_16x16x32_bf16 v[24:27], a[196:199], a[40:43], v[24:27]
    ds_read_b64_tr_b16 a[206:207], v253 offset:3336
    v_add_f32 v226, v224, v226
    v_mfma_f32_16x16x32_bf16 v[24:27], a[208:211], a[56:59], v[24:27]
    global_load_lds_dwordx4 v239, s[28:29] offset:0
    ds_read_b64_tr_b16 a[228:229], v253 offset:256
    v_mfma_f32_16x16x32_bf16 v[28:31], a[196:199], a[44:47], v[28:31]
    ds_read_b64_tr_b16 a[230:231], v253 offset:3584
    v_add_f32 v227, v225, v227
    v_mfma_f32_16x16x32_bf16 v[28:31], a[208:211], a[60:63], v[28:31]
    ds_read_b64_tr_b16 a[252:253], v253 offset:264
    v_lshlrev_b32 v228, 16, v210
    v_mfma_f32_16x16x32_bf16 v[32:35], a[220:223], a[32:35], v[32:35]
    global_load_lds_dwordx4 v239, s[28:29] offset:1024
    ds_read_b64_tr_b16 a[254:255], v253 offset:3592
    v_mfma_f32_16x16x32_bf16 v[32:35], a[232:235], a[48:51], v[32:35]
    ds_read_b64_tr_b16 a[148:149], v253 offset:512
    v_and_b32 v229, 0xffff0000, v210
    v_mfma_f32_16x16x32_bf16 v[36:39], a[220:223], a[36:39], v[36:39]
    ds_read_b64_tr_b16 a[150:151], v253 offset:3840
    v_add_f32 v228, v226, v228
    v_mfma_f32_16x16x32_bf16 v[36:39], a[232:235], a[52:55], v[36:39]
    global_load_lds_dwordx4 v239, s[28:29] offset:2048
    ds_read_b64_tr_b16 a[156:157], v253 offset:520
    v_mfma_f32_16x16x32_bf16 v[40:43], a[220:223], a[40:43], v[40:43]
    ds_read_b64_tr_b16 a[158:159], v253 offset:3848
    v_add_f32 v229, v227, v229
    v_mfma_f32_16x16x32_bf16 v[40:43], a[232:235], a[56:59], v[40:43]
    ds_read_b64_tr_b16 a[164:165], v254 offset:0
    v_lshlrev_b32 v230, 16, v211
    v_mfma_f32_16x16x32_bf16 v[44:47], a[220:223], a[44:47], v[44:47]
    s_mov_b32 exec_hi, 0
    global_load_lds_dwordx4 v239, s[28:29] offset:3072
    s_mov_b32 exec_hi, -1
    v_mfma_f32_16x16x32_bf16 v[44:47], a[232:235], a[60:63], v[44:47]
    s_add_u32 m0, s35, 96256
    ds_read_b64_tr_b16 a[166:167], v254 offset:3328
    v_and_b32 v231, 0xffff0000, v211
    v_mfma_f32_16x16x32_bf16 v[48:51], a[244:247], a[32:35], v[48:51]
    s_add_u32 s28, s6, 295936
    v_add_f32 v230, v228, v230
    v_add_f32 v231, v229, v231
    v_mfma_f32_16x16x32_bf16 v[48:51], a[176:179], a[48:51], v[48:51]
    s_addc_u32 s29, s7, 0
    v_lshlrev_b32 v232, 16, v212
    v_and_b32 v233, 0xffff0000, v212
    v_mfma_f32_16x16x32_bf16 v[52:55], a[244:247], a[36:39], v[52:55]
    global_load_lds_dwordx4 v239, s[28:29] offset:-3072
    v_add_f32 v232, v230, v232
    v_mfma_f32_16x16x32_bf16 v[52:55], a[176:179], a[52:55], v[52:55]
    v_add_f32 v233, v231, v233
    v_lshlrev_b32 v234, 16, v213
    v_mfma_f32_16x16x32_bf16 v[56:59], a[244:247], a[40:43], v[56:59]
    v_and_b32 v235, 0xffff0000, v213
    v_add_f32 v234, v232, v234
    v_mfma_f32_16x16x32_bf16 v[56:59], a[176:179], a[56:59], v[56:59]
    global_load_lds_dwordx4 v239, s[28:29] offset:-2048
    v_add_f32 v235, v233, v235
    v_mfma_f32_16x16x32_bf16 v[60:63], a[244:247], a[44:47], v[60:63]
    v_mfma_f32_16x16x32_bf16 v[60:63], a[176:179], a[60:63], v[60:63]
    v_mfma_f32_16x16x32_bf16 v[64:67], a[188:191], a[32:35], v[64:67]
    global_load_lds_dwordx4 v239, s[28:29] offset:-1024
    v_mfma_f32_16x16x32_bf16 v[64:67], a[200:203], a[48:51], v[64:67]
    v_mfma_f32_16x16x32_bf16 v[68:71], a[188:191], a[36:39], v[68:71]
    s_waitcnt vmcnt(10) lgkmcnt(0)
    s_barrier
    v_mfma_f32_16x16x32_bf16 v[68:71], a[200:203], a[52:55], v[68:71]
    global_load_lds_dwordx4 v239, s[28:29] offset:0
    ds_read_b64_tr_b16 a[192:193], v253 offset:13312
    v_mfma_f32_16x16x32_bf16 v[72:75], a[188:191], a[40:43], v[72:75]
    ds_read_b64_tr_b16 a[194:195], v253 offset:16640
    v_mfma_f32_16x16x32_bf16 v[72:75], a[200:203], a[56:59], v[72:75]
    ds_read_b64_tr_b16 a[216:217], v253 offset:13320
    v_mfma_f32_16x16x32_bf16 v[76:79], a[188:191], a[44:47], v[76:79]
    global_load_lds_dwordx4 v239, s[28:29] offset:1024
    ds_read_b64_tr_b16 a[218:219], v253 offset:16648
    v_mfma_f32_16x16x32_bf16 v[76:79], a[200:203], a[60:63], v[76:79]
    ds_read_b64_tr_b16 a[240:241], v253 offset:13568
    v_mfma_f32_16x16x32_bf16 v[80:83], a[212:215], a[32:35], v[80:83]
    ds_read_b64_tr_b16 a[242:243], v253 offset:16896
    v_mfma_f32_16x16x32_bf16 v[80:83], a[224:227], a[48:51], v[80:83]
    global_load_lds_dwordx4 v239, s[28:29] offset:2048
    ds_read_b64_tr_b16 a[144:145], v253 offset:13576
    v_mfma_f32_16x16x32_bf16 v[84:87], a[212:215], a[36:39], v[84:87]
    ds_read_b64_tr_b16 a[146:147], v253 offset:16904
    v_mfma_f32_16x16x32_bf16 v[84:87], a[224:227], a[52:55], v[84:87]
    ds_read_b64_tr_b16 a[152:153], v253 offset:13824
    v_mfma_f32_16x16x32_bf16 v[88:91], a[212:215], a[40:43], v[88:91]
    s_mov_b32 exec_hi, 0
    global_load_lds_dwordx4 v239, s[28:29] offset:3072
    s_mov_b32 exec_hi, -1
    v_mfma_f32_16x16x32_bf16 v[88:91], a[224:227], a[56:59], v[88:91]
    ds_read_b64_tr_b16 a[154:155], v253 offset:17152
    v_mfma_f32_16x16x32_bf16 v[92:95], a[212:215], a[44:47], v[92:95]
    ds_read_b64_tr_b16 a[160:161], v253 offset:13832
    v_mfma_f32_16x16x32_bf16 v[92:95], a[224:227], a[60:63], v[92:95]
    s_mov_b64 exec, s[32:33]
    s_cbranch_execz L_skip_poll
    global_load_dword v221, v222, s[12:13] sc1
L_skip_poll:
    s_mov_b64 exec, -1
    v_mfma_f32_16x16x32_bf16 v[96:99], a[236:239], a[32:35], v[96:99]
    s_add_u32 m0, s35, 56320
    ds_read_b64_tr_b16 a[162:163], v253 offset:17160
    s_add_u32 s28, s6, 322560
    v_mfma_f32_16x16x32_bf16 v[96:99], a[248:251], a[48:51], v[96:99]
    s_addc_u32 s29, s7, 0
    ds_read_b64_tr_b16 a[168:169], v254 offset:13312
    v_mfma_f32_16x16x32_bf16 v[100:103], a[236:239], a[36:39], v[100:103]
    global_load_lds_dwordx4 v239, s[28:29] offset:-3072
    ds_read_b64_tr_b16 a[170:171], v254 offset:16640
    v_mfma_f32_16x16x32_bf16 v[100:103], a[248:251], a[52:55], v[100:103]
    v_mfma_f32_16x16x32_bf16 v[0:3], a[180:183], a[64:67], v[0:3]
    s_waitcnt lgkmcnt(12)
    v_mfma_f32_16x16x32_bf16 v[0:3], a[192:195], a[80:83], v[0:3]
    global_load_lds_dwordx4 v239, s[28:29] offset:-2048
    v_mfma_f32_16x16x32_bf16 v[4:7], a[180:183], a[68:71], v[4:7]
    v_mfma_f32_16x16x32_bf16 v[4:7], a[192:195], a[84:87], v[4:7]
    v_mfma_f32_16x16x32_bf16 v[8:11], a[180:183], a[72:75], v[8:11]
    global_load_lds_dwordx4 v239, s[28:29] offset:-1024
    v_mfma_f32_16x16x32_bf16 v[8:11], a[192:195], a[88:91], v[8:11]
    v_mfma_f32_16x16x32_bf16 v[12:15], a[180:183], a[76:79], v[12:15]
    s_waitcnt vmcnt(10) lgkmcnt(0)
    s_barrier
    v_mfma_f32_16x16x32_bf16 v[12:15], a[192:195], a[92:95], v[12:15]
    global_load_lds_dwordx4 v239, s[28:29] offset:0
    ds_read_b64_tr_b16 a[172:173], v253 offset:26624
    v_mfma_f32_16x16x32_bf16 v[16:19], a[204:207], a[64:67], v[16:19]
    ds_read_b64_tr_b16 a[174:175], v253 offset:29952
    v_mfma_f32_16x16x32_bf16 v[16:19], a[216:219], a[80:83], v[16:19]
    ds_read_b64_tr_b16 a[184:185], v253 offset:26632
    v_mfma_f32_16x16x32_bf16 v[20:23], a[204:207], a[68:71], v[20:23]
    global_load_lds_dwordx4 v239, s[28:29] offset:1024
    ds_read_b64_tr_b16 a[186:187], v253 offset:29960
    v_mfma_f32_16x16x32_bf16 v[20:23], a[216:219], a[84:87], v[20:23]
    ds_read_b64_tr_b16 a[196:197], v253 offset:26880
    v_mfma_f32_16x16x32_bf16 v[24:27], a[204:207], a[72:75], v[24:27]
    ds_read_b64_tr_b16 a[198:199], v253 offset:30208
    v_mfma_f32_16x16x32_bf16 v[24:27], a[216:219], a[88:91], v[24:27]
    global_load_lds_dwordx4 v239, s[28:29] offset:2048
    ds_read_b64_tr_b16 a[208:209], v253 offset:26888
    v_mfma_f32_16x16x32_bf16 v[28:31], a[204:207], a[76:79], v[28:31]
    ds_read_b64_tr_b16 a[210:211], v253 offset:30216
    v_mfma_f32_16x16x32_bf16 v[28:31], a[216:219], a[92:95], v[28:31]
    ds_read_b64_tr_b16 a[220:221], v253 offset:27136
    v_mfma_f32_16x16x32_bf16 v[32:35], a[228:231], a[64:67], v[32:35]
    s_mov_b32 exec_hi, 0
    global_load_lds_dwordx4 v239, s[28:29] offset:3072
    s_mov_b32 exec_hi, -1
    v_mfma_f32_16x16x32_bf16 v[32:35], a[240:243], a[80:83], v[32:35]
    s_add_u32 s36, s22, 0
    ds_read_b64_tr_b16 a[222:223], v253 offset:30464
    s_addc_u32 s37, s23, 0
    v_mfma_f32_16x16x32_bf16 v[36:39], a[228:231], a[68:71], v[36:39]
    s_bfe_i32 s100, s0, 0x10000
    ds_read_b64_tr_b16 a[232:233], v253 offset:27144
    s_and_b32 s101, s100, 0x7ff
    v_mfma_f32_16x16x32_bf16 v[36:39], a[240:243], a[84:87], v[36:39]
    s_lshr_b32 s0, s0, 1
    ds_read_b64_tr_b16 a[234:235], v253 offset:30472
    v_mfma_f32_16x16x32_bf16 v[40:43], a[228:231], a[72:75], v[40:43]
    ds_read_b64_tr_b16 a[244:245], v254 offset:26624
    v_mfma_f32_16x16x32_bf16 v[40:43], a[240:243], a[88:91], v[40:43]
    ds_read_b64_tr_b16 a[246:247], v254 offset:29952
L_join:
    v_mfma_f32_16x16x32_bf16 v[44:47], a[228:231], a[76:79], v[44:47]
    v_mfma_f32_16x16x32_bf16 v[44:47], a[240:243], a[92:95], v[44:47]
    v_mfma_f32_16x16x32_bf16 v[48:51], a[252:255], a[64:67], v[48:51]
    s_waitcnt vmcnt(7)
    v_cmp_ne_u32 vcc, 27, v221
    s_nop 1
    s_cbranch_vccnz L_slow
L_slow_back:
    s_barrier
    v_mfma_f32_16x16x32_bf16 v[48:51], a[144:147], a[80:83], v[48:51]
    s_mov_b64 exec, s[100:101]
    s_cbranch_execz L_skip_pf1
    global_load_dword v239, v252, s[36:37] sc1
L_skip_pf1:
    s_mov_b64 exec, -1
    v_mfma_f32_16x16x32_bf16 v[52:55], a[252:255], a[68:71], v[52:55]
    ds_read_b64_tr_b16 a[176:177], v253 offset:39936
    v_mfma_f32_16x16x32_bf16 v[52:55], a[144:147], a[84:87], v[52:55]
    ds_read_b64_tr_b16 a[178:179], v253 offset:43264
    v_mfma_f32_16x16x32_bf16 v[56:59], a[252:255], a[72:75], v[56:59]
    ds_read_b64_tr_b16 a[188:189], v253 offset:39944
    v_mfma_f32_16x16x32_bf16 v[56:59], a[144:147], a[88:91], v[56:59]
    s_add_u32 s18, s22, 4096
    ds_read_b64_tr_b16 a[190:191], v253 offset:43272
    s_addc_u32 s19, s23, 0
    v_mfma_f32_16x16x32_bf16 v[60:63], a[252:255], a[76:79], v[60:63]
    ds_read_b64_tr_b16 a[200:201], v253 offset:40192
    v_mfma_f32_16x16x32_bf16 v[60:63], a[144:147], a[92:95], v[60:63]
    ds_read_b64_tr_b16 a[202:203], v253 offset:43520
    v_mfma_f32_16x16x32_bf16 v[64:67], a[148:151], a[64:67], v[64:67]
    global_load_dwordx4 a[144:147], v246, s[18:19] offset:-4096 sc1
    ds_read_b64_tr_b16 a[212:213], v253 offset:40200
    v_mfma_f32_16x16x32_bf16 v[64:67], a[152:155], a[80:83], v[64:67]
    ds_read_b64_tr_b16 a[214:215], v253 offset:43528
    v_mfma_f32_16x16x32_bf16 v[68:71], a[148:151], a[68:71], v[68:71]
    ds_read_b64_tr_b16 a[224:225], v253 offset:40448
    v_mfma_f32_16x16x32_bf16 v[68:71], a[152:155], a[84:87], v[68:71]
    ds_read_b64_tr_b16 a[226:227], v253 offset:43776
    v_mfma_f32_16x16x32_bf16 v[72:75], a[148:151], a[72:75], v[72:75]
    ds_read_b64_tr_b16 a[236:237], v253 offset:40456
    v_mfma_f32_16x16x32_bf16 v[72:75], a[152:155], a[88:91], v[72:75]
    ds_read_b64_tr_b16 a[238:239], v253 offset:43784
    v_mfma_f32_16x16x32_bf16 v[76:79], a[148:151], a[76:79], v[76:79]
    ds_read_b64_tr_b16 a[248:249], v254 offset:39936
    v_mfma_f32_16x16x32_bf16 v[76:79], a[152:155], a[92:95], v[76:79]
    global_load_dwordx4 a[148:151], v246, s[18:19] offset:-2048 sc1
    ds_read_b64_tr_b16 a[250:251], v254 offset:43264
    v_mfma_f32_16x16x32_bf16 v[80:83], a[156:159], a[64:67], v[80:83]
    s_waitcnt vmcnt(2)
    s_barrier
    v_mfma_f32_16x16x32_bf16 v[80:83], a[160:163], a[80:83], v[80:83]
    ds_write_b64 v217, v[224:225] offset:0
    v_mfma_f32_16x16x32_bf16 v[84:87], a[156:159], a[68:71], v[84:87]
    global_load_dwordx4 a[152:155], v246, s[18:19] offset:-3072 sc1
    ds_read_b64_tr_b16 a[180:181], v253 offset:0
    v_mfma_f32_16x16x32_bf16 v[84:87], a[160:163], a[84:87], v[84:87]
    ds_read_b64_tr_b16 a[182:183], v253 offset:3328
    v_mfma_f32_16x16x32_bf16 v[88:91], a[156:159], a[72:75], v[88:91]
    ds_write_b64 v217, v[226:227] offset:2048
    v_mfma_f32_16x16x32_bf16 v[88:91], a[160:163], a[88:91], v[88:91]
    ds_write_b64 v217, v[228:229] offset:4096
    v_mfma_f32_16x16x32_bf16 v[92:95], a[156:159], a[76:79], v[92:95]
    ds_read_b64_tr_b16 a[192:193], v253 offset:8
    v_mfma_f32_16x16x32_bf16 v[92:95], a[160:163], a[92:95], v[92:95]
    global_load_dwordx4 a[156:159], v246, s[18:19] offset:-1024 sc1
    ds_read_b64_tr_b16 a[194:195], v253 offset:3336
    v_mfma_f32_16x16x32_bf16 v[96:99], a[164:167], a[64:67], v[96:99]
    ds_write_b64 v217, v[230:231] offset:6144
    v_mfma_f32_16x16x32_bf16 v[96:99], a[168:171], a[80:83], v[96:99]
    ds_write_b64 v217, v[232:233] offset:8192
    v_mfma_f32_16x16x32_bf16 v[100:103], a[164:167], a[68:71], v[100:103]
    global_load_dwordx4 a[160:163], v246, s[18:19] offset:0 sc1
    ds_read_b64_tr_b16 a[204:205], v253 offset:256
    v_mfma_f32_16x16x32_bf16 v[100:103], a[168:171], a[84:87], v[100:103]
    s_waitcnt lgkmcnt(14)
    ds_write_b64 v217, v[234:235] offset:10240
    v_mfma_f32_16x16x32_bf16 v[0:3], a[172:175], a[96:99], v[0:3]
    ds_read_b64_tr_b16 a[206:207], v253 offset:3584
    v_mfma_f32_16x16x32_bf16 v[0:3], a[176:179], a[112:115], v[0:3]
    s_waitcnt lgkmcnt(9)
    global_load_dwordx4 a[164:167], v246, s[18:19] offset:2048 sc1
    ds_read_b64_tr_b16 a[216:217], v253 offset:264
    v_mfma_f32_16x16x32_bf16 v[0:3], a[180:183], a[128:131], v[0:3]
    s_waitcnt lgkmcnt(2)
    s_barrier
    v_mfma_f32_16x16x32_bf16 v[16:19], a[184:187], a[96:99], v[16:19]
    ds_read_b128 v[208:211], v245 offset:0
    v_mfma_f32_16x16x32_bf16 v[16:19], a[188:191], a[112:115], v[16:19]
    global_load_dwordx4 a[168:171], v246, s[18:19] offset:1024 sc1
    ds_read_b128 v[212:215], v245 offset:16
    v_mfma_f32_16x16x32_bf16 v[16:19], a[192:195], a[128:131], v[16:19]
    ds_read_b64_tr_b16 a[218:219], v253 offset:3592
    v_mfma_f32_16x16x32_bf16 v[4:7], a[172:175], a[100:103], v[4:7]
    ds_read_b64_tr_b16 a[228:229], v253 offset:512
    v_mfma_f32_16x16x32_bf16 v[4:7], a[176:179], a[116:119], v[4:7]
    ds_read_b64_tr_b16 a[230:231], v253 offset:3840
    v_mfma_f32_16x16x32_bf16 v[4:7], a[180:183], a[132:135], v[4:7]
    ds_read_b64_tr_b16 a[240:241], v253 offset:520
    v_mfma_f32_16x16x32_bf16 v[20:23], a[184:187], a[100:103], v[20:23]
    ds_read_b64_tr_b16 a[242:243], v253 offset:3848
    v_mfma_f32_16x16x32_bf16 v[20:23], a[188:191], a[116:119], v[20:23]
    s_waitcnt lgkmcnt(6)
    ds_read_b64_tr_b16 a[252:253], v254 offset:0
    v_add_f32 v224, v0, v208
    v_mfma_f32_16x16x32_bf16 v[20:23], a[192:195], a[132:135], v[20:23]
    ds_read_b64_tr_b16 a[254:255], v254 offset:3328
    v_add_f32 v225, v1, v209
    v_mfma_f32_16x16x32_bf16 v[8:11], a[172:175], a[104:107], v[8:11]
    v_add_f32 v226, v2, v210
    v_add_f32 v227, v3, v211
    v_mfma_f32_16x16x32_bf16 v[8:11], a[176:179], a[120:123], v[8:11]
    v_mul_f32 v224, v224, v104
    v_mul_f32 v225, v225, v105
    v_mfma_f32_16x16x32_bf16 v[8:11], a[180:183], a[136:139], v[8:11]
    ds_read_b128 v[216:219], v245 offset:512
    v_mul_f32 v226, v226, v106
    v_mfma_f32_16x16x32_bf16 v[24:27], a[184:187], a[104:107], v[24:27]
    ds_read_b128 v[220:223], v245 offset:528
    v_mul_f32 v227, v227, v107
    v_mfma_f32_16x16x32_bf16 v[24:27], a[188:191], a[120:123], v[24:27]
    v_cvt_pk_bf16_f32 v232, v224, v225
    v_cvt_pk_bf16_f32 v233, v226, v227
    v_mfma_f32_16x16x32_bf16 v[24:27], a[192:195], a[136:139], v[24:27]
    s_waitcnt lgkmcnt(9)
    v_add_f32 v228, v16, v212
    v_add_f32 v229, v17, v213
    v_mfma_f32_16x16x32_bf16 v[12:15], a[172:175], a[108:111], v[12:15]
    v_add_f32 v230, v18, v214
    v_add_f32 v231, v19, v215
    v_mfma_f32_16x16x32_bf16 v[12:15], a[176:179], a[124:127], v[12:15]
    global_load_dwordx4 a[172:175], v246, s[18:19] offset:3072 sc1
    v_mul_f32 v228, v228, v108
    v_mfma_f32_16x16x32_bf16 v[12:15], a[180:183], a[140:143], v[12:15]
    s_add_u32 s18, s22, 30720
    v_mul_f32 v229, v229, v109
    v_mul_f32 v230, v230, v110
    v_mfma_f32_16x16x32_bf16 v[28:31], a[184:187], a[108:111], v[28:31]
    s_addc_u32 s19, s23, 0
    v_mul_f32 v231, v231, v111
    v_cvt_pk_bf16_f32 v234, v228, v229
    v_mfma_f32_16x16x32_bf16 v[28:31], a[188:191], a[124:127], v[28:31]
    global_load_dwordx4 a[176:179], v246, s[18:19] offset:-4096 sc1
    v_cvt_pk_bf16_f32 v235, v230, v231
    v_mfma_f32_16x16x32_bf16 v[28:31], a[192:195], a[140:143], v[28:31]
    ds_write_b128 v242, v[232:235] offset:0
    v_mfma_f32_16x16x32_bf16 v[32:35], a[196:199], a[96:99], v[32:35]
    v_add_f32 v224, v4, v208
    v_add_f32 v225, v5, v209
    v_mfma_f32_16x16x32_bf16 v[32:35], a[200:203], a[112:115], v[32:35]
    global_load_dwordx4 a[180:183], v246, s[18:19] offset:-2048 sc1
    v_add_f32 v226, v6, v210
    v_mfma_f32_16x16x32_bf16 v[32:35], a[204:207], a[128:131], v[32:35]
    v_add_f32 v227, v7, v211
    v_mul_f32 v224, v224, v112
    v_mfma_f32_16x16x32_bf16 v[36:39], a[196:199], a[100:103], v[36:39]
    v_mul_f32 v225, v225, v113
    v_mul_f32 v226, v226, v114
    v_mfma_f32_16x16x32_bf16 v[36:39], a[200:203], a[116:119], v[36:39]
    global_load_dwordx4 a[184:187], v246, s[18:19] offset:-3072 sc1
    v_mul_f32 v227, v227, v115
    v_mfma_f32_16x16x32_bf16 v[36:39], a[204:207], a[132:135], v[36:39]
    v_cvt_pk_bf16_f32 v236, v224, v225
    v_cvt_pk_bf16_f32 v237, v226, v227
    v_mfma_f32_16x16x32_bf16 v[40:43], a[196:199], a[104:107], v[40:43]
    v_add_f32 v228, v20, v212
    v_add_f32 v229, v21, v213
    v_mfma_f32_16x16x32_bf16 v[40:43], a[200:203], a[120:123], v[40:43]
    global_load_dwordx4 a[188:191], v246, s[18:19] offset:-1024 sc1
    v_add_f32 v230, v22, v214
    v_mfma_f32_16x16x32_bf16 v[40:43], a[204:207], a[136:139], v[40:43]
    v_add_f32 v231, v23, v215
    v_mul_f32 v228, v228, v116
    v_mfma_f32_16x16x32_bf16 v[44:47], a[196:199], a[108:111], v[44:47]
    v_mul_f32 v229, v229, v117
    v_mul_f32 v230, v230, v118
    v_mfma_f32_16x16x32_bf16 v[44:47], a[200:203], a[124:127], v[44:47]
    global_load_dwordx4 a[192:195], v246, s[18:19] offset:0 sc1
    v_mul_f32 v231, v231, v119
    v_mfma_f32_16x16x32_bf16 v[44:47], a[204:207], a[140:143], v[44:47]
    v_cvt_pk_bf16_f32 v238, v228, v229
    v_cvt_pk_bf16_f32 v239, v230, v231
    v_mfma_f32_16x16x32_bf16 v[48:51], a[208:211], a[96:99], v[48:51]
    ds_write_b128 v242, v[236:239] offset:1024
    v_mfma_f32_16x16x32_bf16 v[48:51], a[212:215], a[112:115], v[48:51]
    s_waitcnt lgkmcnt(10)
    global_load_dwordx4 a[196:199], v246, s[18:19] offset:2048 sc1
    v_add_f32 v224, v8, v208
    v_mfma_f32_16x16x32_bf16 v[48:51], a[216:219], a[128:131], v[48:51]
    v_add_f32 v225, v9, v209
    v_add_f32 v226, v10, v210
    v_mfma_f32_16x16x32_bf16 v[52:55], a[208:211], a[100:103], v[52:55]
    v_add_f32 v227, v11, v211
    v_mul_f32 v224, v224, v120
    v_mfma_f32_16x16x32_bf16 v[52:55], a[212:215], a[116:119], v[52:55]
    global_load_dwordx4 a[200:203], v246, s[18:19] offset:1024 sc1
    v_mul_f32 v225, v225, v121
    v_mfma_f32_16x16x32_bf16 v[52:55], a[216:219], a[132:135], v[52:55]
    v_mul_f32 v226, v226, v122
    v_mul_f32 v227, v227, v123
    v_mfma_f32_16x16x32_bf16 v[56:59], a[208:211], a[104:107], v[56:59]
    v_cvt_pk_bf16_f32 v232, v224, v225
    v_cvt_pk_bf16_f32 v233, v226, v227
    v_mfma_f32_16x16x32_bf16 v[56:59], a[212:215], a[120:123], v[56:59]
    global_load_dwordx4 a[204:207], v246, s[18:19] offset:3072 sc1
    v_add_f32 v228, v24, v212
    v_mfma_f32_16x16x32_bf16 v[56:59], a[216:219], a[136:139], v[56:59]
    s_add_u32 s18, s22, 12288
    v_add_f32 v229, v25, v213
    v_add_f32 v230, v26, v214
    v_mfma_f32_16x16x32_bf16 v[60:63], a[208:211], a[108:111], v[60:63]
    s_addc_u32 s19, s23, 0
    v_add_f32 v231, v27, v215
    v_mul_f32 v228, v228, v124
    v_mfma_f32_16x16x32_bf16 v[60:63], a[212:215], a[124:127], v[60:63]
    global_load_dwordx4 a[208:211], v246, s[18:19] offset:-4096 sc1
    v_mul_f32 v229, v229, v125
    v_mfma_f32_16x16x32_bf16 v[60:63], a[216:219], a[140:143], v[60:63]
    v_mul_f32 v230, v230, v126
    v_mul_f32 v231, v231, v127
    v_mfma_f32_16x16x32_bf16 v[64:67], a[220:223], a[96:99], v[64:67]
    v_cvt_pk_bf16_f32 v234, v228, v229
    v_cvt_pk_bf16_f32 v235, v230, v231
    v_mfma_f32_16x16x32_bf16 v[64:67], a[224:227], a[112:115], v[64:67]
    s_waitcnt lgkmcnt(8)
    global_load_dwordx4 a[212:215], v246, s[18:19] offset:-2048 sc1
    v_add_f32 v224, v12, v208
    v_mfma_f32_16x16x32_bf16 v[64:67], a[228:231], a[128:131], v[64:67]
    ds_write_b128 v243, v[232:235] offset:0
    v_mfma_f32_16x16x32_bf16 v[68:71], a[220:223], a[100:103], v[68:71]
    v_add_f32 v225, v13, v209
    v_add_f32 v226, v14, v210
    v_mfma_f32_16x16x32_bf16 v[68:71], a[224:227], a[116:119], v[68:71]
    global_load_dwordx4 a[216:219], v246, s[18:19] offset:-3072 sc1
    v_add_f32 v227, v15, v211
    v_mfma_f32_16x16x32_bf16 v[68:71], a[228:231], a[132:135], v[68:71]
    v_mul_f32 v224, v224, v128
    v_mul_f32 v225, v225, v129
    v_mfma_f32_16x16x32_bf16 v[72:75], a[220:223], a[104:107], v[72:75]
    v_mul_f32 v226, v226, v130
    v_mul_f32 v227, v227, v131
    v_mfma_f32_16x16x32_bf16 v[72:75], a[224:227], a[120:123], v[72:75]
    v_cvt_pk_bf16_f32 v236, v224, v225
    v_cvt_pk_bf16_f32 v237, v226, v227
    v_mfma_f32_16x16x32_bf16 v[72:75], a[228:231], a[136:139], v[72:75]
    v_add_f32 v228, v28, v212
    v_add_f32 v229, v29, v213
    v_mfma_f32_16x16x32_bf16 v[76:79], a[220:223], a[108:111], v[76:79]
    v_add_f32 v230, v30, v214
    v_add_f32 v231, v31, v215
    v_mfma_f32_16x16x32_bf16 v[76:79], a[224:227], a[124:127], v[76:79]
    global_load_dwordx4 a[220:223], v246, s[18:19] offset:-1024 sc1
    ds_read_b128 v[208:211], v245 offset:1024
    v_mfma_f32_16x16x32_bf16 v[76:79], a[228:231], a[140:143], v[76:79]
    ds_read_b128 v[212:215], v245 offset:1040
    v_mul_f32 v228, v228, v132
    v_mfma_f32_16x16x32_bf16 v[80:83], a[232:235], a[96:99], v[80:83]
    v_mul_f32 v229, v229, v133
    v_mul_f32 v230, v230, v134
    v_mfma_f32_16x16x32_bf16 v[80:83], a[236:239], a[112:115], v[80:83]
    s_waitcnt lgkmcnt(9)
    global_load_dwordx4 a[224:227], v246, s[18:19] offset:0 sc1
    v_mul_f32 v231, v231, v135
    v_mfma_f32_16x16x32_bf16 v[80:83], a[240:243], a[128:131], v[80:83]
    v_cvt_pk_bf16_f32 v238, v228, v229
    v_cvt_pk_bf16_f32 v239, v230, v231
    v_mfma_f32_16x16x32_bf16 v[84:87], a[232:235], a[100:103], v[84:87]
    ds_write_b128 v243, v[236:239] offset:1024
    v_mfma_f32_16x16x32_bf16 v[84:87], a[236:239], a[116:119], v[84:87]
    s_waitcnt lgkmcnt(0)
    s_barrier
    v_mfma_f32_16x16x32_bf16 v[84:87], a[240:243], a[132:135], v[84:87]
    global_load_dwordx4 a[228:231], v246, s[18:19] offset:2048 sc1
    ds_read_b128 a[64:67], v240 offset:0
    v_mfma_f32_16x16x32_bf16 v[88:91], a[232:235], a[104:107], v[88:91]
    ds_read_b128 a[80:83], v240 offset:4096
    v_add_f32 v224, v32, v216
    v_mfma_f32_16x16x32_bf16 v[88:91], a[236:239], a[120:123], v[88:91]
    ds_read_b128 a[68:71], v240 offset:1024
    v_add_f32 v225, v33, v217
    v_mfma_f32_16x16x32_bf16 v[88:91], a[240:243], a[136:139], v[88:91]
    ds_read_b128 a[84:87], v240 offset:5120
    v_add_f32 v226, v34, v218
    v_mfma_f32_16x16x32_bf16 v[92:95], a[232:235], a[108:111], v[92:95]
    ds_read_b128 a[72:75], v241 offset:0
    v_add_f32 v227, v35, v219
    v_mfma_f32_16x16x32_bf16 v[92:95], a[236:239], a[124:127], v[92:95]
    global_load_dwordx4 a[232:235], v246, s[18:19] offset:1024 sc1
    ds_read_b128 a[88:91], v241 offset:4096
    v_mfma_f32_16x16x32_bf16 v[92:95], a[240:243], a[140:143], v[92:95]
    ds_read_b128 a[76:79], v241 offset:1024
    v_mul_f32 v224, v224, v136
    v_mfma_f32_16x16x32_bf16 v[96:99], a[244:247], a[96:99], v[96:99]
    ds_read_b128 a[92:95], v241 offset:5120
    v_mul_f32 v225, v225, v137
    v_mfma_f32_16x16x32_bf16 v[96:99], a[248:251], a[112:115], v[96:99]
    ds_read_b128 a[96:99], v240 offset:8192
    v_mul_f32 v226, v226, v138
    v_mfma_f32_16x16x32_bf16 v[96:99], a[252:255], a[128:131], v[96:99]
    ds_read_b128 a[112:115], v240 offset:12288
    v_mul_f32 v227, v227, v139
    v_mfma_f32_16x16x32_bf16 v[100:103], a[244:247], a[100:103], v[100:103]
    v_cvt_pk_bf16_f32 v232, v224, v225
    v_cvt_pk_bf16_f32 v233, v226, v227
    v_mfma_f32_16x16x32_bf16 v[100:103], a[248:251], a[116:119], v[100:103]
    ds_read_b128 a[100:103], v240 offset:9216
    v_add_f32 v228, v48, v220
    v_mfma_f32_16x16x32_bf16 v[100:103], a[252:255], a[132:135], v[100:103]
    s_waitcnt vmcnt(22) lgkmcnt(10)
    ds_read_b128 a[116:119], v240 offset:13312
    v_add_f32 v229, v49, v221
    v_mfma_f32_16x16x32_bf16 v[0:3], a[144:147], a[64:67], v[0:3]
    s_waitcnt vmcnt(21) lgkmcnt(10)
    ds_read_b128 a[104:107], v241 offset:8192
    v_add_f32 v230, v50, v222
    v_mfma_f32_16x16x32_bf16 v[0:3], a[148:151], a[80:83], v[0:3]
    s_waitcnt lgkmcnt(9)
    ds_read_b128 a[120:123], v241 offset:12288
    v_add_f32 v231, v51, v223
    v_mfma_f32_16x16x32_bf16 v[4:7], a[144:147], a[68:71], v[4:7]
    ds_read_b128 a[108:111], v241 offset:9216
    v_mul_f32 v228, v228, v140
    v_mfma_f32_16x16x32_bf16 v[4:7], a[148:151], a[84:87], v[4:7]
    s_waitcnt lgkmcnt(9)
    ds_read_b128 a[124:127], v241 offset:13312
    v_mul_f32 v229, v229, v141
    v_mfma_f32_16x16x32_bf16 v[8:11], a[144:147], a[72:75], v[8:11]
    v_mul_f32 v230, v230, v142
    v_mul_f32 v231, v231, v143
    v_mfma_f32_16x16x32_bf16 v[8:11], a[148:151], a[88:91], v[8:11]
    s_waitcnt lgkmcnt(8)
    v_cvt_pk_bf16_f32 v234, v228, v229
    v_cvt_pk_bf16_f32 v235, v230, v231
    v_mfma_f32_16x16x32_bf16 v[12:15], a[144:147], a[76:79], v[12:15]
    ds_write_b128 v242, v[232:235] offset:16384
    v_mfma_f32_16x16x32_bf16 v[12:15], a[148:151], a[92:95], v[12:15]
    s_waitcnt vmcnt(19)
    global_load_dwordx4 a[144:147], v246, s[18:19] offset:3072 sc1
    v_add_f32 v224, v36, v216
    v_mfma_f32_16x16x32_bf16 v[16:19], a[152:155], a[64:67], v[16:19]
    s_add_u32 s18, s22, 57344
    v_add_f32 v225, v37, v217
    v_add_f32 v226, v38, v218
    v_mfma_f32_16x16x32_bf16 v[16:19], a[156:159], a[80:83], v[16:19]
    s_addc_u32 s19, s23, 0
    v_add_f32 v227, v39, v219
    v_mul_f32 v224, v224, v144
    v_mfma_f32_16x16x32_bf16 v[20:23], a[152:155], a[68:71], v[20:23]
    global_load_dwordx4 a[148:151], v246, s[18:19] offset:-4096 sc1
    v_mul_f32 v225, v225, v145
    v_mfma_f32_16x16x32_bf16 v[20:23], a[156:159], a[84:87], v[20:23]
    v_mul_f32 v226, v226, v146
    v_mul_f32 v227, v227, v147
    v_mfma_f32_16x16x32_bf16 v[24:27], a[152:155], a[72:75], v[24:27]
    v_cvt_pk_bf16_f32 v236, v224, v225
    v_cvt_pk_bf16_f32 v237, v226, v227
    v_mfma_f32_16x16x32_bf16 v[24:27], a[156:159], a[88:91], v[24:27]
    v_add_f32 v228, v52, v220
    v_add_f32 v229, v53, v221
    v_mfma_f32_16x16x32_bf16 v[28:31], a[152:155], a[76:79], v[28:31]
    v_add_f32 v230, v54, v222
    v_add_f32 v231, v55, v223
    v_mfma_f32_16x16x32_bf16 v[28:31], a[156:159], a[92:95], v[28:31]
    s_waitcnt vmcnt(19) lgkmcnt(7)
    global_load_dwordx4 a[152:155], v246, s[18:19] offset:-2048 sc1
    v_mul_f32 v228, v228, v148
    v_mfma_f32_16x16x32_bf16 v[0:3], a[160:163], a[96:99], v[0:3]
    v_mul_f32 v229, v229, v149
    v_mul_f32 v230, v230, v150
    v_mfma_f32_16x16x32_bf16 v[0:3], a[164:167], a[112:115], v[0:3]
    s_waitcnt lgkmcnt(5)
    global_load_dwordx4 a[156:159], v246, s[18:19] offset:-3072 sc1
    v_mul_f32 v231, v231, v151
    v_mfma_f32_16x16x32_bf16 v[4:7], a[160:163], a[100:103], v[4:7]
    v_cvt_pk_bf16_f32 v238, v228, v229
    v_cvt_pk_bf16_f32 v239, v230, v231
    v_mfma_f32_16x16x32_bf16 v[4:7], a[164:167], a[116:119], v[4:7]
    s_waitcnt lgkmcnt(3)
    ds_write_b128 v242, v[236:239] offset:17408
    v_mfma_f32_16x16x32_bf16 v[8:11], a[160:163], a[104:107], v[8:11]
    v_add_f32 v224, v40, v216
    v_add_f32 v225, v41, v217
    v_mfma_f32_16x16x32_bf16 v[8:11], a[164:167], a[120:123], v[8:11]
    s_waitcnt lgkmcnt(2)
    v_add_f32 v226, v42, v218
    v_add_f32 v227, v43, v219
    v_mfma_f32_16x16x32_bf16 v[12:15], a[160:163], a[108:111], v[12:15]
    v_mul_f32 v224, v224, v152
    v_mul_f32 v225, v225, v153
    v_mfma_f32_16x16x32_bf16 v[12:15], a[164:167], a[124:127], v[12:15]
    s_waitcnt vmcnt(19)
    global_load_dwordx4 a[160:163], v246, s[18:19] offset:-1024 sc1
    v_mul_f32 v226, v226, v154
    v_mfma_f32_16x16x32_bf16 v[16:19], a[168:171], a[96:99], v[16:19]
    s_add_u32 s20, s22, 4096
    v_mul_f32 v227, v227, v155
    v_cvt_pk_bf16_f32 v232, v224, v225
    v_mfma_f32_16x16x32_bf16 v[16:19], a[172:175], a[112:115], v[16:19]
    s_addc_u32 s21, s23, 0
    v_cvt_pk_bf16_f32 v233, v226, v227
    v_add_f32 v228, v56, v220
    v_mfma_f32_16x16x32_bf16 v[20:23], a[168:171], a[100:103], v[20:23]
    global_load_dwordx4 a[164:167], v247, s[20:21] offset:-4096
    v_add_f32 v229, v57, v221
    v_mfma_f32_16x16x32_bf16 v[20:23], a[172:175], a[116:119], v[20:23]
    v_add_f32 v230, v58, v222
    v_add_f32 v231, v59, v223
    v_mfma_f32_16x16x32_bf16 v[24:27], a[168:171], a[104:107], v[24:27]
    v_mul_f32 v228, v228, v156
    v_mul_f32 v229, v229, v157
    v_mfma_f32_16x16x32_bf16 v[24:27], a[172:175], a[120:123], v[24:27]
    v_mul_f32 v230, v230, v158
    v_mul_f32 v231, v231, v159
    v_mfma_f32_16x16x32_bf16 v[28:31], a[168:171], a[108:111], v[28:31]
    v_cvt_pk_bf16_f32 v234, v228, v229
    v_cvt_pk_bf16_f32 v235, v230, v231
    v_mfma_f32_16x16x32_bf16 v[28:31], a[172:175], a[124:127], v[28:31]
    s_waitcnt vmcnt(19)
    global_load_dwordx4 a[168:171], v247, s[20:21] offset:-3072
    v_add_f32 v224, v44, v216
    v_mfma_f32_16x16x32_bf16 v[32:35], a[176:179], a[64:67], v[32:35]
    ds_write_b128 v243, v[232:235] offset:16384
    v_mfma_f32_16x16x32_bf16 v[32:35], a[180:183], a[80:83], v[32:35]
    global_load_dwordx4 a[172:175], v246, s[18:19] offset:0 sc1
    v_add_f32 v225, v45, v217
    v_mfma_f32_16x16x32_bf16 v[36:39], a[176:179], a[68:71], v[36:39]
    v_add_f32 v226, v46, v218
    v_add_f32 v227, v47, v219
    v_mfma_f32_16x16x32_bf16 v[36:39], a[180:183], a[84:87], v[36:39]
    v_mul_f32 v224, v224, v160
    v_mul_f32 v225, v225, v161
    v_mfma_f32_16x16x32_bf16 v[40:43], a[176:179], a[72:75], v[40:43]
    v_mul_f32 v226, v226, v162
    v_mul_f32 v227, v227, v163
    v_mfma_f32_16x16x32_bf16 v[40:43], a[180:183], a[88:91], v[40:43]
    v_cvt_pk_bf16_f32 v236, v224, v225
    v_cvt_pk_bf16_f32 v237, v226, v227
    v_mfma_f32_16x16x32_bf16 v[44:47], a[176:179], a[76:79], v[44:47]
    v_add_f32 v228, v60, v220
    v_add_f32 v229, v61, v221
    v_mfma_f32_16x16x32_bf16 v[44:47], a[180:183], a[92:95], v[44:47]
    s_waitcnt vmcnt(19)
    global_load_dwordx4 a[176:179], v246, s[18:19] offset:2048 sc1
    v_add_f32 v230, v62, v222
    v_mfma_f32_16x16x32_bf16 v[48:51], a[184:187], a[64:67], v[48:51]
    v_add_f32 v231, v63, v223
    v_mul_f32 v228, v228, v164
    v_mfma_f32_16x16x32_bf16 v[48:51], a[188:191], a[80:83], v[48:51]
    global_load_dwordx4 a[180:183], v246, s[18:19] offset:1024 sc1
    ds_read_b128 v[216:219], v251 offset:0
    v_mfma_f32_16x16x32_bf16 v[52:55], a[184:187], a[68:71], v[52:55]
    v_mul_f32 v229, v229, v165
    v_mul_f32 v230, v230, v166
    v_mfma_f32_16x16x32_bf16 v[52:55], a[188:191], a[84:87], v[52:55]
    v_mul_f32 v231, v231, v167
    v_cvt_pk_bf16_f32 v238, v228, v229
    v_mfma_f32_16x16x32_bf16 v[56:59], a[184:187], a[72:75], v[56:59]
    v_cvt_pk_bf16_f32 v239, v230, v231
    v_add_f32 v224, v64, v208
    v_mfma_f32_16x16x32_bf16 v[56:59], a[188:191], a[88:91], v[56:59]
    ds_write_b128 v243, v[236:239] offset:17408
    v_mfma_f32_16x16x32_bf16 v[60:63], a[184:187], a[76:79], v[60:63]
    v_add_f32 v225, v65, v209
    v_add_f32 v226, v66, v210
    v_mfma_f32_16x16x32_bf16 v[60:63], a[188:191], a[92:95], v[60:63]
    s_waitcnt vmcnt(19)
    global_load_dwordx4 a[184:187], v246, s[18:19] offset:3072 sc1
    v_add_f32 v227, v67, v211
    v_mfma_f32_16x16x32_bf16 v[32:35], a[192:195], a[96:99], v[32:35]
    v_mul_f32 v224, v224, v168
    v_mul_f32 v225, v225, v169
    v_mfma_f32_16x16x32_bf16 v[32:35], a[196:199], a[112:115], v[32:35]
    global_load_dwordx4 a[188:191], v247, s[20:21] offset:-2048
    v_mul_f32 v226, v226, v170
    v_mfma_f32_16x16x32_bf16 v[36:39], a[192:195], a[100:103], v[36:39]
    v_mul_f32 v227, v227, v171
    v_cvt_pk_bf16_f32 v232, v224, v225
    v_mfma_f32_16x16x32_bf16 v[36:39], a[196:199], a[116:119], v[36:39]
    s_waitcnt lgkmcnt(0)
    s_barrier
    v_mfma_f32_16x16x32_bf16 v[40:43], a[192:195], a[104:107], v[40:43]
    ds_read_b128 a[0:3], v240 offset:16384
    v_cvt_pk_bf16_f32 v233, v226, v227
    v_mfma_f32_16x16x32_bf16 v[40:43], a[196:199], a[120:123], v[40:43]
    ds_read_b128 a[16:19], v240 offset:20480
    v_add_f32 v228, v80, v212
    v_mfma_f32_16x16x32_bf16 v[44:47], a[192:195], a[108:111], v[44:47]
    ds_read_b128 a[4:7], v240 offset:17408
    v_add_f32 v229, v81, v213
    v_mfma_f32_16x16x32_bf16 v[44:47], a[196:199], a[124:127], v[44:47]
    s_waitcnt vmcnt(19)
    global_load_dwordx4 a[192:195], v247, s[20:21] offset:-1024
    ds_read_b128 a[20:23], v240 offset:21504
    v_mfma_f32_16x16x32_bf16 v[48:51], a[200:203], a[96:99], v[48:51]
    s_add_u32 s18, s22, 38912
    ds_read_b128 a[8:11], v241 offset:16384
    v_add_f32 v230, v82, v214
    v_mfma_f32_16x16x32_bf16 v[48:51], a[204:207], a[112:115], v[48:51]
    s_addc_u32 s19, s23, 0
    ds_read_b128 a[24:27], v241 offset:20480
    v_add_f32 v231, v83, v215
    v_mfma_f32_16x16x32_bf16 v[52:55], a[200:203], a[100:103], v[52:55]
    global_load_dwordx4 a[196:199], v246, s[18:19] offset:-4096 sc1
    ds_read_b128 a[12:15], v241 offset:17408
    v_mfma_f32_16x16x32_bf16 v[52:55], a[204:207], a[116:119], v[52:55]
    ds_read_b128 a[28:31], v241 offset:21504
    v_mul_f32 v228, v228, v172
    v_mfma_f32_16x16x32_bf16 v[56:59], a[200:203], a[104:107], v[56:59]
    ds_read_b128 a[32:35], v240 offset:24576
    v_mul_f32 v229, v229, v173
    v_mfma_f32_16x16x32_bf16 v[56:59], a[204:207], a[120:123], v[56:59]
    ds_read_b128 a[48:51], v240 offset:28672
    v_mul_f32 v230, v230, v174
    v_mfma_f32_16x16x32_bf16 v[60:63], a[200:203], a[108:111], v[60:63]
    ds_read_b128 a[36:39], v240 offset:25600
    v_mul_f32 v231, v231, v175
    v_mfma_f32_16x16x32_bf16 v[60:63], a[204:207], a[124:127], v[60:63]
    s_waitcnt vmcnt(19) lgkmcnt(9)
    global_load_dwordx4 a[200:203], v246, s[18:19] offset:-2048 sc1
    ds_read_b128 a[52:55], v240 offset:29696
    v_mfma_f32_16x16x32_bf16 v[0:3], a[208:211], a[0:3], v[0:3]
    ds_read_b128 a[40:43], v241 offset:24576
    v_cvt_pk_bf16_f32 v234, v228, v229
    v_mfma_f32_16x16x32_bf16 v[0:3], a[212:215], a[16:19], v[0:3]
    s_waitcnt lgkmcnt(9)
    global_load_dwordx4 a[204:207], v246, s[18:19] offset:-3072 sc1
    ds_read_b128 a[56:59], v241 offset:28672
    v_mfma_f32_16x16x32_bf16 v[4:7], a[208:211], a[4:7], v[4:7]
    ds_read_b128 a[44:47], v241 offset:25600
    v_cvt_pk_bf16_f32 v235, v230, v231
    v_mfma_f32_16x16x32_bf16 v[4:7], a[212:215], a[20:23], v[4:7]
    s_waitcnt lgkmcnt(9)
    ds_write_b128 v242, v[232:235] offset:32768
    v_mfma_f32_16x16x32_bf16 v[8:11], a[208:211], a[8:11], v[8:11]
    ds_read_b128 a[60:63], v241 offset:29696
    v_add_f32 v224, v68, v208
    v_mfma_f32_16x16x32_bf16 v[8:11], a[212:215], a[24:27], v[8:11]
    s_waitcnt lgkmcnt(9)
    v_add_f32 v225, v69, v209
    v_add_f32 v226, v70, v210
    v_mfma_f32_16x16x32_bf16 v[12:15], a[208:211], a[12:15], v[12:15]
    v_add_f32 v227, v71, v211
    v_mul_f32 v224, v224, v176
    v_mfma_f32_16x16x32_bf16 v[12:15], a[212:215], a[28:31], v[12:15]
    s_waitcnt vmcnt(19)
    global_load_dwordx4 a[208:211], v246, s[18:19] offset:-1024 sc1
    v_mul_f32 v225, v225, v177
    v_mfma_f32_16x16x32_bf16 v[16:19], a[216:219], a[0:3], v[16:19]
    v_mul_f32 v226, v226, v178
    v_mul_f32 v227, v227, v179
    v_mfma_f32_16x16x32_bf16 v[16:19], a[220:223], a[16:19], v[16:19]
    global_load_dwordx4 a[212:215], v246, s[18:19] offset:0 sc1
    v_cvt_pk_bf16_f32 v236, v224, v225
    v_mfma_f32_16x16x32_bf16 v[20:23], a[216:219], a[4:7], v[20:23]
    v_cvt_pk_bf16_f32 v237, v226, v227
    v_add_f32 v228, v84, v212
    v_mfma_f32_16x16x32_bf16 v[20:23], a[220:223], a[20:23], v[20:23]
    v_add_f32 v229, v85, v213
    v_add_f32 v230, v86, v214
    v_mfma_f32_16x16x32_bf16 v[24:27], a[216:219], a[8:11], v[24:27]
    v_add_f32 v231, v87, v215
    v_mul_f32 v228, v228, v180
    v_mfma_f32_16x16x32_bf16 v[24:27], a[220:223], a[24:27], v[24:27]
    v_mul_f32 v229, v229, v181
    v_mul_f32 v230, v230, v182
    v_mfma_f32_16x16x32_bf16 v[28:31], a[216:219], a[12:15], v[28:31]
    v_mul_f32 v231, v231, v183
    v_cvt_pk_bf16_f32 v238, v228, v229
    v_mfma_f32_16x16x32_bf16 v[28:31], a[220:223], a[28:31], v[28:31]
    s_waitcnt vmcnt(19) lgkmcnt(7)
    global_load_dwordx4 a[216:219], v246, s[18:19] offset:2048 sc1
    v_cvt_pk_bf16_f32 v239, v230, v231
    v_mfma_f32_16x16x32_bf16 v[0:3], a[224:227], a[32:35], v[0:3]
    ds_write_b128 v242, v[236:239] offset:33792
    v_mfma_f32_16x16x32_bf16 v[0:3], a[228:231], a[48:51], v[0:3]
    s_waitcnt lgkmcnt(6)
    global_load_dwordx4 a[220:223], v246, s[18:19] offset:1024 sc1
    v_add_f32 v224, v72, v208
    v_mfma_f32_16x16x32_bf16 v[4:7], a[224:227], a[36:39], v[4:7]
    v_add_f32 v225, v73, v209
    v_add_f32 v226, v74, v210
    v_mfma_f32_16x16x32_bf16 v[4:7], a[228:231], a[52:55], v[4:7]
    s_waitcnt lgkmcnt(4)
    v_add_f32 v227, v75, v211
    v_mul_f32 v224, v224, v184
    v_mfma_f32_16x16x32_bf16 v[8:11], a[224:227], a[40:43], v[8:11]
    v_mul_f32 v225, v225, v185
    v_mul_f32 v226, v226, v186
    v_mfma_f32_16x16x32_bf16 v[8:11], a[228:231], a[56:59], v[8:11]
    s_waitcnt lgkmcnt(1)
    v_mul_f32 v227, v227, v187
    v_cvt_pk_bf16_f32 v232, v224, v225
    v_mfma_f32_16x16x32_bf16 v[12:15], a[224:227], a[44:47], v[12:15]
    v_cvt_pk_bf16_f32 v233, v226, v227
    v_add_f32 v228, v88, v212
    v_mfma_f32_16x16x32_bf16 v[12:15], a[228:231], a[60:63], v[12:15]
    s_waitcnt vmcnt(19)
    global_load_dwordx4 a[224:227], v246, s[18:19] offset:3072 sc1
    v_add_f32 v229, v89, v213
    v_mfma_f32_16x16x32_bf16 v[16:19], a[232:235], a[32:35], v[16:19]
    s_add_u32 s18, s22, 20480
    v_add_f32 v230, v90, v214
    v_add_f32 v231, v91, v215
    v_mfma_f32_16x16x32_bf16 v[16:19], a[144:147], a[48:51], v[16:19]
    s_addc_u32 s19, s23, 0
    v_mul_f32 v228, v228, v188
    v_mul_f32 v229, v229, v189
    v_mfma_f32_16x16x32_bf16 v[20:23], a[232:235], a[36:39], v[20:23]
    global_load_dwordx4 a[228:231], v246, s[18:19] offset:-4096 sc1
    v_mul_f32 v230, v230, v190
    v_mfma_f32_16x16x32_bf16 v[20:23], a[144:147], a[52:55], v[20:23]
    s_add_u32 s36, s22, 352256
    v_mul_f32 v231, v231, v191
    v_cvt_pk_bf16_f32 v234, v228, v229
    v_mfma_f32_16x16x32_bf16 v[24:27], a[232:235], a[40:43], v[24:27]
    s_addc_u32 s37, s23, 0
    v_cvt_pk_bf16_f32 v235, v230, v231
    v_add_f32 v224, v76, v208
    v_mfma_f32_16x16x32_bf16 v[24:27], a[144:147], a[56:59], v[24:27]
    s_bfe_i32 s100, s0, 0x10000
    ds_write_b128 v243, v[232:235] offset:32768
    v_mfma_f32_16x16x32_bf16 v[28:31], a[232:235], a[44:47], v[28:31]
    s_and_b32 s101, s100, 0x7ff
    v_add_f32 v225, v77, v209
    v_add_f32 v226, v78, v210
    v_mfma_f32_16x16x32_bf16 v[28:31], a[144:147], a[60:63], v[28:31]
    s_waitcnt vmcnt(19)
    v_add_f32 v227, v79, v211
    v_mul_f32 v224, v224, v192
    v_mfma_f32_16x16x32_bf16 v[64:67], a[148:151], a[64:67], v[64:67]
    s_lshr_b32 s0, s0, 1
    v_mul_f32 v225, v225, v193
    v_mul_f32 v226, v226, v194
    v_mfma_f32_16x16x32_bf16 v[64:67], a[152:155], a[80:83], v[64:67]
    s_mov_b64 exec, s[100:101]
    s_cbranch_execz L_skip_pf2
    global_load_dword v253, v252, s[36:37] sc1
L_skip_pf2:
    s_mov_b64 exec, -1
    v_mfma_f32_16x16x32_bf16 v[68:71], a[148:151], a[68:71], v[68:71]
    v_mul_f32 v227, v227, v195
    v_cvt_pk_bf16_f32 v236, v224, v225
    v_mfma_f32_16x16x32_bf16 v[68:71], a[152:155], a[84:87], v[68:71]
    global_load_dwordx4 a[232:235], v246, s[18:19] offset:-2048 sc1
    v_cvt_pk_bf16_f32 v237, v226, v227
    v_mfma_f32_16x16x32_bf16 v[72:75], a[148:151], a[72:75], v[72:75]
    v_add_f32 v228, v92, v212
    v_add_f32 v229, v93, v213
    v_mfma_f32_16x16x32_bf16 v[72:75], a[152:155], a[88:91], v[72:75]
    global_load_dwordx4 a[144:147], v246, s[18:19] offset:-3072 sc1
    v_add_f32 v230, v94, v214
    v_mfma_f32_16x16x32_bf16 v[76:79], a[148:151], a[76:79], v[76:79]
    v_add_f32 v231, v95, v215
    v_mul_f32 v228, v228, v196
    v_mfma_f32_16x16x32_bf16 v[76:79], a[152:155], a[92:95], v[76:79]
    s_waitcnt vmcnt(19)
    global_load_dwordx4 a[148:151], v246, s[18:19] offset:-1024 sc1
    v_mul_f32 v229, v229, v197
    v_mfma_f32_16x16x32_bf16 v[80:83], a[156:159], a[64:67], v[80:83]
    v_mul_f32 v230, v230, v198
    v_mul_f32 v231, v231, v199
    v_mfma_f32_16x16x32_bf16 v[80:83], a[160:163], a[80:83], v[80:83]
    global_load_dwordx4 a[152:155], v246, s[18:19] offset:0 sc1
    v_cvt_pk_bf16_f32 v238, v228, v229
    v_mfma_f32_16x16x32_bf16 v[84:87], a[156:159], a[68:71], v[84:87]
    v_cvt_pk_bf16_f32 v239, v230, v231
    v_add_f32 v224, v96, v216
    v_mfma_f32_16x16x32_bf16 v[84:87], a[160:163], a[84:87], v[84:87]
    ds_write_b128 v243, v[236:239] offset:33792
    v_mfma_f32_16x16x32_bf16 v[88:91], a[156:159], a[72:75], v[88:91]
    v_add_f32 v225, v97, v217
    v_add_f32 v226, v98, v218
    v_mfma_f32_16x16x32_bf16 v[88:91], a[160:163], a[88:91], v[88:91]
    v_add_f32 v227, v99, v219
    v_mul_f32 v224, v224, v200
    v_mfma_f32_16x16x32_bf16 v[92:95], a[156:159], a[76:79], v[92:95]
    v_mul_f32 v225, v225, v201
    v_mul_f32 v226, v226, v202
    v_mfma_f32_16x16x32_bf16 v[92:95], a[160:163], a[92:95], v[92:95]
    s_waitcnt vmcnt(19)
    global_load_dwordx4 a[156:159], v246, s[18:19] offset:2048 sc1
    v_mul_f32 v227, v227, v203
    v_mfma_f32_16x16x32_bf16 v[96:99], a[164:167], a[64:67], v[96:99]
    s_add_u32 s18, s22, 28672
    v_cvt_pk_bf16_f32 v232, v224, v225
    v_cvt_pk_bf16_f32 v233, v226, v227
    v_mfma_f32_16x16x32_bf16 v[96:99], a[168:171], a[80:83], v[96:99]
    s_addc_u32 s19, s23, 0
    ds_write_b64 v244, v[232:233] offset:0
    global_load_dwordx4 a[160:163], v246, s[18:19] offset:-4096 sc1
    v_add_f32 v224, v100, v216
    s_add_u32 s18, s22, 25600
    v_add_f32 v225, v101, v217
    v_add_f32 v226, v102, v218
    s_addc_u32 s19, s23, 0
    v_add_f32 v227, v103, v219
    v_mul_f32 v224, v224, v204
    v_mfma_f32_16x16x32_bf16 v[100:103], a[164:167], a[68:71], v[100:103]
    v_mul_f32 v225, v225, v205
    v_mul_f32 v226, v226, v206
    v_mfma_f32_16x16x32_bf16 v[100:103], a[168:171], a[84:87], v[100:103]
    s_waitcnt vmcnt(19)
    global_load_dwordx4 a[164:167], v246, s[18:19] offset:-4096 sc1
    v_mul_f32 v227, v227, v207
    v_mfma_f32_16x16x32_bf16 v[64:67], a[172:175], a[96:99], v[64:67]
    s_add_u32 s81, s80, 22528
    v_cvt_pk_bf16_f32 v236, v224, v225
    v_cvt_pk_bf16_f32 v237, v226, v227
    v_mfma_f32_16x16x32_bf16 v[64:67], a[176:179], a[112:115], v[64:67]
    buffer_load_dwordx4 a[168:171], off, s[72:75], s81 offset:1024 sc1
    v_mfma_f32_16x16x32_bf16 v[68:71], a[172:175], a[100:103], v[68:71]
    ds_write_b64 v244, v[236:237] offset:1024
    v_mfma_f32_16x16x32_bf16 v[68:71], a[176:179], a[116:119], v[68:71]
    v_mfma_f32_16x16x32_bf16 v[72:75], a[172:175], a[104:107], v[72:75]
    v_mfma_f32_16x16x32_bf16 v[72:75], a[176:179], a[120:123], v[72:75]
    v_mfma_f32_16x16x32_bf16 v[76:79], a[172:175], a[108:111], v[76:79]
    v_mfma_f32_16x16x32_bf16 v[76:79], a[176:179], a[124:127], v[76:79]
    s_waitcnt vmcnt(19)
    buffer_load_dwordx4 a[172:175], off, s[72:75], s81 offset:3072 sc1
    v_mfma_f32_16x16x32_bf16 v[80:83], a[180:183], a[96:99], v[80:83]
    s_add_u32 s81, s80, 61440
    v_mfma_f32_16x16x32_bf16 v[80:83], a[184:187], a[112:115], v[80:83]
    buffer_load_dwordx4 a[176:179], off, s[72:75], s81 offset:0 sc1
    v_mfma_f32_16x16x32_bf16 v[84:87], a[180:183], a[100:103], v[84:87]
    v_mfma_f32_16x16x32_bf16 v[84:87], a[184:187], a[116:119], v[84:87]
    v_mfma_f32_16x16x32_bf16 v[88:91], a[180:183], a[104:107], v[88:91]
    v_mfma_f32_16x16x32_bf16 v[88:91], a[184:187], a[120:123], v[88:91]
    v_mfma_f32_16x16x32_bf16 v[92:95], a[180:183], a[108:111], v[92:95]
    v_mfma_f32_16x16x32_bf16 v[92:95], a[184:187], a[124:127], v[92:95]
    s_waitcnt vmcnt(19)
    buffer_load_dwordx4 a[180:183], off, s[72:75], s81 offset:2048 sc1
    v_mfma_f32_16x16x32_bf16 v[96:99], a[188:191], a[96:99], v[96:99]
    v_mfma_f32_16x16x32_bf16 v[96:99], a[192:195], a[112:115], v[96:99]
L_loop:
    v_mfma_f32_16x16x32_bf16 v[100:103], a[188:191], a[100:103], v[100:103]
    buffer_load_dwordx4 a[184:187], off, s[72:75], s81 offset:1024 sc1
    v_mfma_f32_16x16x32_bf16 v[100:103], a[192:195], a[116:119], v[100:103]
    s_waitcnt vmcnt(19)
    v_mfma_f32_16x16x32_bf16 v[32:35], a[196:199], a[0:3], v[32:35]
    buffer_load_dwordx4 a[188:191], off, s[72:75], s81 offset:3072 sc1
    v_mfma_f32_16x16x32_bf16 v[32:35], a[200:203], a[16:19], v[32:35]
    s_add_u32 s82, s80, 4096
    v_mfma_f32_16x16x32_bf16 v[36:39], a[196:199], a[4:7], v[36:39]
    buffer_load_dwordx4 a[192:195], off, s[76:79], s82 offset:0
    v_mfma_f32_16x16x32_bf16 v[36:39], a[200:203], a[20:23], v[36:39]
    v_mfma_f32_16x16x32_bf16 v[40:43], a[196:199], a[8:11], v[40:43]
    v_mfma_f32_16x16x32_bf16 v[40:43], a[200:203], a[24:27], v[40:43]
    v_mfma_f32_16x16x32_bf16 v[44:47], a[196:199], a[12:15], v[44:47]
    v_mfma_f32_16x16x32_bf16 v[44:47], a[200:203], a[28:31], v[44:47]
    s_waitcnt vmcnt(19)
    buffer_load_dwordx4 a[196:199], off, s[76:79], s82 offset:1024
    v_mfma_f32_16x16x32_bf16 v[48:51], a[204:207], a[0:3], v[48:51]
    s_add_u32 s81, s80, 65536
    v_mfma_f32_16x16x32_bf16 v[48:51], a[208:211], a[16:19], v[48:51]
    buffer_load_dwordx4 a[200:203], off, s[72:75], s81 offset:0 sc1
    v_mfma_f32_16x16x32_bf16 v[52:55], a[204:207], a[4:7], v[52:55]
    v_mfma_f32_16x16x32_bf16 v[52:55], a[208:211], a[20:23], v[52:55]
    v_mfma_f32_16x16x32_bf16 v[56:59], a[204:207], a[8:11], v[56:59]
    v_mfma_f32_16x16x32_bf16 v[56:59], a[208:211], a[24:27], v[56:59]
    v_mfma_f32_16x16x32_bf16 v[60:63], a[204:207], a[12:15], v[60:63]
    s_waitcnt lgkmcnt(0)
    s_barrier
    v_mfma_f32_16x16x32_bf16 v[60:63], a[208:211], a[28:31], v[60:63]
    s_waitcnt vmcnt(19)
    buffer_load_dwordx4 a[204:207], off, s[72:75], s81 offset:2048 sc1
    v_mfma_f32_16x16x32_bf16 v[32:35], a[212:215], a[32:35], v[32:35]
    ds_read_b128 a[64:67], v240 offset:32768
    v_mfma_f32_16x16x32_bf16 v[32:35], a[216:219], a[48:51], v[32:35]
    buffer_load_dwordx4 a[208:211], off, s[72:75], s81 offset:1024 sc1
    v_mfma_f32_16x16x32_bf16 v[36:39], a[212:215], a[36:39], v[36:39]
    ds_read_b128 a[80:83], v240 offset:36864
    v_mfma_f32_16x16x32_bf16 v[36:39], a[216:219], a[52:55], v[36:39]
    ds_read_b128 a[68:71], v240 offset:33792
    v_mfma_f32_16x16x32_bf16 v[40:43], a[212:215], a[40:43], v[40:43]
    ds_read_b128 a[84:87], v240 offset:37888
    v_mfma_f32_16x16x32_bf16 v[40:43], a[216:219], a[56:59], v[40:43]
    ds_read_b128 a[72:75], v241 offset:32768
    v_mfma_f32_16x16x32_bf16 v[44:47], a[212:215], a[44:47], v[44:47]
    ds_read_b128 a[88:91], v241 offset:36864
    v_mfma_f32_16x16x32_bf16 v[44:47], a[216:219], a[60:63], v[44:47]
    s_waitcnt vmcnt(19)
    buffer_load_dwordx4 a[212:215], off, s[72:75], s81 offset:3072 sc1
    v_mfma_f32_16x16x32_bf16 v[48:51], a[220:223], a[32:35], v[48:51]
    ds_read_b128 a[76:79], v241 offset:33792
    v_mfma_f32_16x16x32_bf16 v[48:51], a[224:227], a[48:51], v[48:51]
    buffer_load_dwordx4 a[216:219], off, s[76:79], s82 offset:2048
    v_mfma_f32_16x16x32_bf16 v[52:55], a[220:223], a[36:39], v[52:55]
    ds_read_b128 a[92:95], v241 offset:37888
    v_mfma_f32_16x16x32_bf16 v[52:55], a[224:227], a[52:55], v[52:55]
    ds_read_b128 a[96:99], v240 offset:40960
    v_mfma_f32_16x16x32_bf16 v[56:59], a[220:223], a[40:43], v[56:59]
    ds_read_b128 a[112:115], v240 offset:45056
    v_mfma_f32_16x16x32_bf16 v[56:59], a[224:227], a[56:59], v[56:59]
    ds_read_b128 a[128:131], v240 offset:49152
    v_mfma_f32_16x16x32_bf16 v[60:63], a[220:223], a[44:47], v[60:63]
    ds_read_b128 a[100:103], v240 offset:41984
    v_mfma_f32_16x16x32_bf16 v[60:63], a[224:227], a[60:63], v[60:63]
    s_waitcnt vmcnt(19) lgkmcnt(10)
    buffer_load_dwordx4 a[220:223], off, s[76:79], s82 offset:3072
    v_mfma_f32_16x16x32_bf16 v[0:3], a[228:231], a[64:67], v[0:3]
    s_add_u32 s81, s80, 43008
    ds_read_b128 a[116:119], v240 offset:46080
    v_mfma_f32_16x16x32_bf16 v[0:3], a[232:235], a[80:83], v[0:3]
    s_waitcnt lgkmcnt(9)
    buffer_load_dwordx4 a[224:227], off, s[72:75], s81 offset:0 sc1
    v_mfma_f32_16x16x32_bf16 v[4:7], a[228:231], a[68:71], v[4:7]
    ds_read_b128 a[132:135], v240 offset:50176
    v_mfma_f32_16x16x32_bf16 v[4:7], a[232:235], a[84:87], v[4:7]
    s_waitcnt lgkmcnt(8)
    ds_read_b128 a[104:107], v241 offset:40960
    v_mfma_f32_16x16x32_bf16 v[8:11], a[228:231], a[72:75], v[8:11]
    ds_read_b128 a[120:123], v241 offset:45056
    v_mfma_f32_16x16x32_bf16 v[8:11], a[232:235], a[88:91], v[8:11]
    s_waitcnt lgkmcnt(8)
    ds_read_b128 a[136:139], v241 offset:49152
    v_mfma_f32_16x16x32_bf16 v[12:15], a[228:231], a[76:79], v[12:15]
    ds_read_b128 v[208:211], v245 offset:2048
    v_mfma_f32_16x16x32_bf16 v[12:15], a[232:235], a[92:95], v[12:15]
    s_waitcnt vmcnt(19)
    buffer_load_dwordx4 a[228:231], off, s[72:75], s81 offset:2048 sc1
    v_mfma_f32_16x16x32_bf16 v[16:19], a[144:147], a[64:67], v[16:19]
    ds_read_b128 v[212:215], v245 offset:2064
    v_mfma_f32_16x16x32_bf16 v[16:19], a[148:151], a[80:83], v[16:19]
    buffer_load_dwordx4 a[232:235], off, s[72:75], s81 offset:1024 sc1
    v_mfma_f32_16x16x32_bf16 v[20:23], a[144:147], a[68:71], v[20:23]
    ds_read_b128 a[108:111], v241 offset:41984
    v_mfma_f32_16x16x32_bf16 v[20:23], a[148:151], a[84:87], v[20:23]
    ds_read_b128 a[124:127], v241 offset:46080
    v_mfma_f32_16x16x32_bf16 v[24:27], a[144:147], a[72:75], v[24:27]
    ds_read_b128 a[140:143], v241 offset:50176
    v_mfma_f32_16x16x32_bf16 v[24:27], a[148:151], a[88:91], v[24:27]
    v_mfma_f32_16x16x32_bf16 v[28:31], a[144:147], a[76:79], v[28:31]
    v_mfma_f32_16x16x32_bf16 v[28:31], a[148:151], a[92:95], v[28:31]
    s_waitcnt vmcnt(18) lgkmcnt(11)
    buffer_load_dwordx4 a[144:147], off, s[72:75], s81 offset:3072 sc1
    v_mfma_f32_16x16x32_bf16 v[0:3], a[152:155], a[96:99], v[0:3]
    s_add_u32 s81, s80, 47104
    v_mfma_f32_16x16x32_bf16 v[0:3], a[156:159], a[112:115], v[0:3]
    buffer_load_dwordx4 a[148:151], off, s[72:75], s81 offset:0 sc1
    v_mfma_f32_16x16x32_bf16 v[0:3], a[160:163], a[128:131], v[0:3]
    s_waitcnt lgkmcnt(8)
    v_mfma_f32_16x16x32_bf16 v[4:7], a[152:155], a[100:103], v[4:7]
    v_mfma_f32_16x16x32_bf16 v[4:7], a[156:159], a[116:119], v[4:7]
    v_mfma_f32_16x16x32_bf16 v[4:7], a[160:163], a[132:135], v[4:7]
    s_waitcnt lgkmcnt(5)
    v_mfma_f32_16x16x32_bf16 v[8:11], a[152:155], a[104:107], v[8:11]
    v_mfma_f32_16x16x32_bf16 v[8:11], a[156:159], a[120:123], v[8:11]
    v_mfma_f32_16x16x32_bf16 v[8:11], a[160:163], a[136:139], v[8:11]
    s_waitcnt lgkmcnt(0)
    v_mfma_f32_16x16x32_bf16 v[12:15], a[152:155], a[108:111], v[12:15]
    v_mfma_f32_16x16x32_bf16 v[12:15], a[156:159], a[124:127], v[12:15]
    buffer_load_dwordx4 a[152:155], off, s[72:75], s81 offset:2048 sc1
    v_mfma_f32_16x16x32_bf16 v[12:15], a[160:163], a[140:143], v[12:15]
    s_waitcnt vmcnt(18)
    v_add_f32 v224, v0, v208
    v_add_f32 v225, v1, v209
    v_mfma_f32_16x16x32_bf16 v[16:19], a[164:167], a[96:99], v[16:19]
    s_add_u32 s81, s80, 51200
    v_add_f32 v226, v2, v210
    v_add_f32 v227, v3, v211
    v_mfma_f32_16x16x32_bf16 v[16:19], a[168:171], a[112:115], v[16:19]
    buffer_load_dwordx4 a[156:159], off, s[72:75], s81 offset:0 sc1
    v_mfma_f32_16x16x32_bf16 v[16:19], a[172:175], a[128:131], v[16:19]
    s_add_u32 s81, s80, 47104
    v_mul_f32 v224, v224, v104
    v_mul_f32 v225, v225, v105
    v_mfma_f32_16x16x32_bf16 v[20:23], a[164:167], a[100:103], v[20:23]
    buffer_load_dwordx4 a[160:163], off, s[72:75], s81 offset:1024 sc1
    v_mfma_f32_16x16x32_bf16 v[20:23], a[168:171], a[116:119], v[20:23]
    v_mul_f32 v226, v226, v106
    v_mul_f32 v227, v227, v107
    v_mfma_f32_16x16x32_bf16 v[20:23], a[172:175], a[132:135], v[20:23]
    v_cvt_pk_bf16_f32 v232, v224, v225
    v_cvt_pk_bf16_f32 v233, v226, v227
    v_mfma_f32_16x16x32_bf16 v[24:27], a[164:167], a[104:107], v[24:27]
    v_mfma_f32_16x16x32_bf16 v[24:27], a[168:171], a[120:123], v[24:27]
    v_mfma_f32_16x16x32_bf16 v[24:27], a[172:175], a[136:139], v[24:27]
    v_mfma_f32_16x16x32_bf16 v[28:31], a[164:167], a[108:111], v[28:31]
    v_mfma_f32_16x16x32_bf16 v[28:31], a[168:171], a[124:127], v[28:31]
    buffer_load_dwordx4 a[164:167], off, s[72:75], s81 offset:3072 sc1
    v_mfma_f32_16x16x32_bf16 v[28:31], a[172:175], a[140:143], v[28:31]
    s_waitcnt vmcnt(19)
    v_add_f32 v228, v16, v212
    v_add_f32 v229, v17, v213
    v_mfma_f32_16x16x32_bf16 v[64:67], a[176:179], a[0:3], v[64:67]
    s_add_u32 s81, s80, 51200
    v_add_f32 v230, v18, v214
    v_add_f32 v231, v19, v215
    v_mfma_f32_16x16x32_bf16 v[64:67], a[180:183], a[16:19], v[64:67]
    buffer_load_dwordx4 a[168:171], off, s[72:75], s81 offset:1024 sc1
    v_mfma_f32_16x16x32_bf16 v[68:71], a[176:179], a[4:7], v[68:71]
    s_add_u32 s81, s80, 69632
    v_mul_f32 v228, v228, v108
    v_mul_f32 v229, v229, v109
    v_mfma_f32_16x16x32_bf16 v[68:71], a[180:183], a[20:23], v[68:71]
    buffer_load_dwordx4 a[172:175], off, s[72:75], s81 offset:0 sc1
    v_mfma_f32_16x16x32_bf16 v[72:75], a[176:179], a[8:11], v[72:75]
    v_mul_f32 v230, v230, v110
    v_mul_f32 v231, v231, v111
    v_mfma_f32_16x16x32_bf16 v[72:75], a[180:183], a[24:27], v[72:75]
    v_cvt_pk_bf16_f32 v234, v228, v229
    v_cvt_pk_bf16_f32 v235, v230, v231
    v_mfma_f32_16x16x32_bf16 v[76:79], a[176:179], a[12:15], v[76:79]
    ds_write_b128 v242, v[232:235] offset:0
    v_mfma_f32_16x16x32_bf16 v[76:79], a[180:183], a[28:31], v[76:79]
    s_waitcnt vmcnt(19)
    buffer_load_dwordx4 a[176:179], off, s[72:75], s81 offset:2048 sc1
    v_mfma_f32_16x16x32_bf16 v[80:83], a[184:187], a[0:3], v[80:83]
    v_add_f32 v224, v4, v208
    v_add_f32 v225, v5, v209
    v_mfma_f32_16x16x32_bf16 v[80:83], a[188:191], a[16:19], v[80:83]
    buffer_load_dwordx4 a[180:183], off, s[72:75], s81 offset:1024 sc1
    v_mfma_f32_16x16x32_bf16 v[84:87], a[184:187], a[4:7], v[84:87]
    v_add_f32 v226, v6, v210
    v_add_f32 v227, v7, v211
    v_mfma_f32_16x16x32_bf16 v[84:87], a[188:191], a[20:23], v[84:87]
    v_mul_f32 v224, v224, v112
    v_mul_f32 v225, v225, v113
    v_mfma_f32_16x16x32_bf16 v[88:91], a[184:187], a[8:11], v[88:91]
    v_mul_f32 v226, v226, v114
    v_mul_f32 v227, v227, v115
    v_mfma_f32_16x16x32_bf16 v[88:91], a[188:191], a[24:27], v[88:91]
    v_cvt_pk_bf16_f32 v236, v224, v225
    v_cvt_pk_bf16_f32 v237, v226, v227
    v_mfma_f32_16x16x32_bf16 v[92:95], a[184:187], a[12:15], v[92:95]
    v_add_f32 v228, v20, v212
    v_add_f32 v229, v21, v213
    v_mfma_f32_16x16x32_bf16 v[92:95], a[188:191], a[28:31], v[92:95]
    s_waitcnt vmcnt(19)
    buffer_load_dwordx4 a[184:187], off, s[72:75], s81 offset:3072 sc1
    v_mfma_f32_16x16x32_bf16 v[96:99], a[192:195], a[0:3], v[96:99]
    s_add_u32 s82, s80, 8192
    v_add_f32 v230, v22, v214
    v_add_f32 v231, v23, v215
    v_mfma_f32_16x16x32_bf16 v[96:99], a[196:199], a[16:19], v[96:99]
    buffer_load_dwordx4 a[188:191], off, s[76:79], s82 offset:0
    v_mfma_f32_16x16x32_bf16 v[100:103], a[192:195], a[4:7], v[100:103]
    v_mul_f32 v228, v228, v116
    v_mul_f32 v229, v229, v117
    v_mfma_f32_16x16x32_bf16 v[100:103], a[196:199], a[20:23], v[100:103]
    s_waitcnt vmcnt(19)
    buffer_load_dwordx4 a[192:195], off, s[76:79], s82 offset:1024
    v_mfma_f32_16x16x32_bf16 v[64:67], a[200:203], a[32:35], v[64:67]
    s_add_u32 s81, s80, 73728
    v_mul_f32 v230, v230, v118
    v_mul_f32 v231, v231, v119
    v_mfma_f32_16x16x32_bf16 v[64:67], a[204:207], a[48:51], v[64:67]
    buffer_load_dwordx4 a[196:199], off, s[72:75], s81 offset:0 sc1
    v_mfma_f32_16x16x32_bf16 v[68:71], a[200:203], a[36:39], v[68:71]
    v_cvt_pk_bf16_f32 v238, v228, v229
    v_cvt_pk_bf16_f32 v239, v230, v231
    v_mfma_f32_16x16x32_bf16 v[68:71], a[204:207], a[52:55], v[68:71]
    ds_write_b128 v242, v[236:239] offset:1024
    v_mfma_f32_16x16x32_bf16 v[72:75], a[200:203], a[40:43], v[72:75]
    v_add_f32 v224, v8, v208
    v_add_f32 v225, v9, v209
    v_mfma_f32_16x16x32_bf16 v[72:75], a[204:207], a[56:59], v[72:75]
    v_add_f32 v226, v10, v210
    v_add_f32 v227, v11, v211
    v_mfma_f32_16x16x32_bf16 v[76:79], a[200:203], a[44:47], v[76:79]
    v_mul_f32 v224, v224, v120
    v_mul_f32 v225, v225, v121
    v_mfma_f32_16x16x32_bf16 v[76:79], a[204:207], a[60:63], v[76:79]
    s_waitcnt vmcnt(19)
    buffer_load_dwordx4 a[200:203], off, s[72:75], s81 offset:2048 sc1
    v_mfma_f32_16x16x32_bf16 v[80:83], a[208:211], a[32:35], v[80:83]
    s_add_u32 s81, s80, 77824
    v_mul_f32 v226, v226, v122
    v_mul_f32 v227, v227, v123
    v_mfma_f32_16x16x32_bf16 v[80:83], a[212:215], a[48:51], v[80:83]
    buffer_load_dwordx4 a[204:207], off, s[72:75], s81 offset:0 sc1
    v_mfma_f32_16x16x32_bf16 v[84:87], a[208:211], a[36:39], v[84:87]
    v_cvt_pk_bf16_f32 v232, v224, v225
    v_cvt_pk_bf16_f32 v233, v226, v227
    v_mfma_f32_16x16x32_bf16 v[84:87], a[212:215], a[52:55], v[84:87]
    v_add_f32 v228, v24, v212
    v_add_f32 v229, v25, v213
    v_mfma_f32_16x16x32_bf16 v[88:91], a[208:211], a[40:43], v[88:91]
    s_add_u32 s81, s80, 73728
    v_add_f32 v230, v26, v214
    v_add_f32 v231, v27, v215
    v_mfma_f32_16x16x32_bf16 v[88:91], a[212:215], a[56:59], v[88:91]
    v_mul_f32 v228, v228, v124
    v_mul_f32 v229, v229, v125
    v_mfma_f32_16x16x32_bf16 v[92:95], a[208:211], a[44:47], v[92:95]
    v_mul_f32 v230, v230, v126
    v_mul_f32 v231, v231, v127
    v_mfma_f32_16x16x32_bf16 v[92:95], a[212:215], a[60:63], v[92:95]
    s_waitcnt vmcnt(19)
    buffer_load_dwordx4 a[208:211], off, s[72:75], s81 offset:1024 sc1
    v_mfma_f32_16x16x32_bf16 v[96:99], a[216:219], a[32:35], v[96:99]
    v_cvt_pk_bf16_f32 v234, v228, v229
    v_cvt_pk_bf16_f32 v235, v230, v231
    v_mfma_f32_16x16x32_bf16 v[96:99], a[220:223], a[48:51], v[96:99]
    buffer_load_dwordx4 a[212:215], off, s[72:75], s81 offset:3072 sc1
    v_mfma_f32_16x16x32_bf16 v[100:103], a[216:219], a[36:39], v[100:103]
    s_add_u32 s81, s80, 77824
    ds_write_b128 v243, v[232:235] offset:0
    v_mfma_f32_16x16x32_bf16 v[100:103], a[220:223], a[52:55], v[100:103]
    s_waitcnt vmcnt(19)
    buffer_load_dwordx4 a[216:219], off, s[72:75], s81 offset:1024 sc1
    v_mfma_f32_16x16x32_bf16 v[32:35], a[224:227], a[64:67], v[32:35]
    v_add_f32 v224, v12, v208
    v_add_f32 v225, v13, v209
    v_mfma_f32_16x16x32_bf16 v[32:35], a[228:231], a[80:83], v[32:35]
    buffer_load_dwordx4 a[220:223], off, s[76:79], s82 offset:2048
    v_mfma_f32_16x16x32_bf16 v[36:39], a[224:227], a[68:71], v[36:39]
    v_add_f32 v226, v14, v210
    v_add_f32 v227, v15, v211
    v_mfma_f32_16x16x32_bf16 v[36:39], a[228:231], a[84:87], v[36:39]
    v_mul_f32 v224, v224, v128
    v_mul_f32 v225, v225, v129
    v_mfma_f32_16x16x32_bf16 v[40:43], a[224:227], a[72:75], v[40:43]
    v_mul_f32 v226, v226, v130
    v_mul_f32 v227, v227, v131
    v_mfma_f32_16x16x32_bf16 v[40:43], a[228:231], a[88:91], v[40:43]
    v_cvt_pk_bf16_f32 v236, v224, v225
    v_cvt_pk_bf16_f32 v237, v226, v227
    v_mfma_f32_16x16x32_bf16 v[44:47], a[224:227], a[76:79], v[44:47]
    ds_read_b128 v[216:219], v245 offset:2560
    v_add_f32 v228, v28, v212
    v_mfma_f32_16x16x32_bf16 v[44:47], a[228:231], a[92:95], v[44:47]
    s_waitcnt vmcnt(19)
    buffer_load_dwordx4 a[224:227], off, s[76:79], s82 offset:3072
    v_mfma_f32_16x16x32_bf16 v[48:51], a[232:235], a[64:67], v[48:51]
    s_add_u32 s82, s80, 12288
    ds_read_b128 v[220:223], v245 offset:2576
    v_add_f32 v229, v29, v213
    v_mfma_f32_16x16x32_bf16 v[48:51], a[144:147], a[80:83], v[48:51]
    buffer_load_dwordx4 a[228:231], off, s[76:79], s82 offset:0
    v_mfma_f32_16x16x32_bf16 v[52:55], a[232:235], a[68:71], v[52:55]
    v_add_f32 v230, v30, v214
    v_add_f32 v231, v31, v215
    v_mfma_f32_16x16x32_bf16 v[52:55], a[144:147], a[84:87], v[52:55]
    v_mul_f32 v228, v228, v132
    v_mul_f32 v229, v229, v133
    v_mfma_f32_16x16x32_bf16 v[56:59], a[232:235], a[72:75], v[56:59]
    v_mul_f32 v230, v230, v134
    v_mul_f32 v231, v231, v135
    v_mfma_f32_16x16x32_bf16 v[56:59], a[144:147], a[88:91], v[56:59]
    s_add_u32 s81, s80, 352256
    v_cvt_pk_bf16_f32 v238, v228, v229
    v_cvt_pk_bf16_f32 v239, v230, v231
    v_mfma_f32_16x16x32_bf16 v[60:63], a[232:235], a[76:79], v[60:63]
    ds_write_b128 v243, v[236:239] offset:1024
    v_mfma_f32_16x16x32_bf16 v[60:63], a[144:147], a[92:95], v[60:63]
    s_waitcnt vmcnt(18)
    v_mfma_f32_16x16x32_bf16 v[32:35], a[148:151], a[96:99], v[32:35]
    buffer_load_dwordx4 a[144:147], off, s[72:75], s81 offset:0 sc1
    v_mfma_f32_16x16x32_bf16 v[32:35], a[152:155], a[112:115], v[32:35]
    v_mfma_f32_16x16x32_bf16 v[32:35], a[156:159], a[128:131], v[32:35]
    v_mfma_f32_16x16x32_bf16 v[36:39], a[148:151], a[100:103], v[36:39]
    v_mfma_f32_16x16x32_bf16 v[36:39], a[152:155], a[116:119], v[36:39]
    v_mfma_f32_16x16x32_bf16 v[36:39], a[156:159], a[132:135], v[36:39]
    v_mfma_f32_16x16x32_bf16 v[40:43], a[148:151], a[104:107], v[40:43]
    v_mfma_f32_16x16x32_bf16 v[40:43], a[152:155], a[120:123], v[40:43]
    v_mfma_f32_16x16x32_bf16 v[40:43], a[156:159], a[136:139], v[40:43]
    v_mfma_f32_16x16x32_bf16 v[44:47], a[148:151], a[108:111], v[44:47]
    v_mfma_f32_16x16x32_bf16 v[44:47], a[152:155], a[124:127], v[44:47]
    buffer_load_dwordx4 a[148:151], off, s[72:75], s81 offset:2048 sc1
    v_mfma_f32_16x16x32_bf16 v[44:47], a[156:159], a[140:143], v[44:47]
    s_waitcnt vmcnt(17) lgkmcnt(2)
    v_add_f32 v224, v32, v216
    v_add_f32 v225, v33, v217
    v_mfma_f32_16x16x32_bf16 v[48:51], a[160:163], a[96:99], v[48:51]
    buffer_load_dwordx4 a[152:155], off, s[72:75], s81 offset:1024 sc1
    v_mfma_f32_16x16x32_bf16 v[48:51], a[164:167], a[112:115], v[48:51]
    v_add_f32 v226, v34, v218
    v_add_f32 v227, v35, v219
    v_mfma_f32_16x16x32_bf16 v[48:51], a[168:171], a[128:131], v[48:51]
    buffer_load_dwordx4 a[156:159], off, s[72:75], s81 offset:3072 sc1
    v_mfma_f32_16x16x32_bf16 v[52:55], a[160:163], a[100:103], v[52:55]
    v_mul_f32 v224, v224, v136
    v_mul_f32 v225, v225, v137
    v_mfma_f32_16x16x32_bf16 v[52:55], a[164:167], a[116:119], v[52:55]
    v_mul_f32 v226, v226, v138
    v_mul_f32 v227, v227, v139
    v_mfma_f32_16x16x32_bf16 v[52:55], a[168:171], a[132:135], v[52:55]
    v_cvt_pk_bf16_f32 v232, v224, v225
    v_cvt_pk_bf16_f32 v233, v226, v227
    v_mfma_f32_16x16x32_bf16 v[56:59], a[160:163], a[104:107], v[56:59]
    v_mfma_f32_16x16x32_bf16 v[56:59], a[164:167], a[120:123], v[56:59]
    s_add_u32 s81, s80, 356352
    v_mfma_f32_16x16x32_bf16 v[56:59], a[168:171], a[136:139], v[56:59]
    v_mfma_f32_16x16x32_bf16 v[60:63], a[160:163], a[108:111], v[60:63]
    v_mfma_f32_16x16x32_bf16 v[60:63], a[164:167], a[124:127], v[60:63]
    buffer_load_dwordx4 a[160:163], off, s[72:75], s81 offset:0 sc1
    v_mfma_f32_16x16x32_bf16 v[60:63], a[168:171], a[140:143], v[60:63]
    s_waitcnt vmcnt(18) lgkmcnt(1)
    v_add_f32 v228, v48, v220
    v_add_f32 v229, v49, v221
    v_mfma_f32_16x16x32_bf16 v[64:67], a[172:175], a[64:67], v[64:67]
    buffer_load_dwordx4 a[164:167], off, s[72:75], s81 offset:2048 sc1
    v_mfma_f32_16x16x32_bf16 v[64:67], a[176:179], a[80:83], v[64:67]
    v_add_f32 v230, v50, v222
    v_add_f32 v231, v51, v223
    v_mfma_f32_16x16x32_bf16 v[68:71], a[172:175], a[68:71], v[68:71]
    buffer_load_dwordx4 a[168:171], off, s[72:75], s81 offset:1024 sc1
    v_mfma_f32_16x16x32_bf16 v[68:71], a[176:179], a[84:87], v[68:71]
    v_mul_f32 v228, v228, v140
    v_mul_f32 v229, v229, v141
    v_mfma_f32_16x16x32_bf16 v[72:75], a[172:175], a[72:75], v[72:75]
    v_mul_f32 v230, v230, v142
    v_mul_f32 v231, v231, v143
    v_mfma_f32_16x16x32_bf16 v[72:75], a[176:179], a[88:91], v[72:75]
    v_cvt_pk_bf16_f32 v234, v228, v229
    v_cvt_pk_bf16_f32 v235, v230, v231
    v_mfma_f32_16x16x32_bf16 v[76:79], a[172:175], a[76:79], v[76:79]
    ds_write_b128 v242, v[232:235] offset:16384
    v_mfma_f32_16x16x32_bf16 v[76:79], a[176:179], a[92:95], v[76:79]
    s_waitcnt vmcnt(18)
    buffer_load_dwordx4 a[172:175], off, s[72:75], s81 offset:3072 sc1
    v_mfma_f32_16x16x32_bf16 v[80:83], a[180:183], a[64:67], v[80:83]
    s_add_u32 s81, s80, 378880
    v_add_f32 v224, v36, v216
    v_add_f32 v225, v37, v217
    v_mfma_f32_16x16x32_bf16 v[80:83], a[184:187], a[80:83], v[80:83]
    buffer_load_dwordx4 a[176:179], off, s[72:75], s81 offset:0 sc1
    v_mfma_f32_16x16x32_bf16 v[84:87], a[180:183], a[68:71], v[84:87]
    ds_read_b128 v[208:211], v245 offset:3072
    v_add_f32 v226, v38, v218
    v_mfma_f32_16x16x32_bf16 v[84:87], a[184:187], a[84:87], v[84:87]
    ds_read_b128 v[212:215], v245 offset:3088
    v_add_f32 v227, v39, v219
    v_mfma_f32_16x16x32_bf16 v[88:91], a[180:183], a[72:75], v[88:91]
    v_mul_f32 v224, v224, v144
    v_mul_f32 v225, v225, v145
    v_mfma_f32_16x16x32_bf16 v[88:91], a[184:187], a[88:91], v[88:91]
    v_mul_f32 v226, v226, v146
    v_mul_f32 v227, v227, v147
    v_mfma_f32_16x16x32_bf16 v[92:95], a[180:183], a[76:79], v[92:95]
    v_cvt_pk_bf16_f32 v236, v224, v225
    v_cvt_pk_bf16_f32 v237, v226, v227
    v_mfma_f32_16x16x32_bf16 v[92:95], a[184:187], a[92:95], v[92:95]
    s_waitcnt vmcnt(18)
    buffer_load_dwordx4 a[180:183], off, s[72:75], s81 offset:2048 sc1
    v_mfma_f32_16x16x32_bf16 v[96:99], a[188:191], a[64:67], v[96:99]
    v_add_f32 v228, v52, v220
    v_add_f32 v229, v53, v221
    v_mfma_f32_16x16x32_bf16 v[96:99], a[192:195], a[80:83], v[96:99]
    buffer_load_dwordx4 a[184:187], off, s[72:75], s81 offset:1024 sc1
    v_mfma_f32_16x16x32_bf16 v[100:103], a[188:191], a[68:71], v[100:103]
    s_waitcnt lgkmcnt(3)
    s_barrier
    v_mfma_f32_16x16x32_bf16 v[100:103], a[192:195], a[84:87], v[100:103]
    s_waitcnt vmcnt(17)
    buffer_load_dwordx4 a[188:191], off, s[72:75], s81 offset:3072 sc1
    v_mfma_f32_16x16x32_bf16 v[64:67], a[196:199], a[96:99], v[64:67]
    s_add_u32 s81, s80, 382976
    ds_read_b128 a[64:67], v240 offset:0
    v_add_f32 v230, v54, v222
    v_mfma_f32_16x16x32_bf16 v[64:67], a[200:203], a[112:115], v[64:67]
    buffer_load_dwordx4 a[192:195], off, s[72:75], s81 offset:0 sc1
    v_mfma_f32_16x16x32_bf16 v[64:67], a[204:207], a[128:131], v[64:67]
    ds_read_b128 a[80:83], v240 offset:4096
    v_add_f32 v231, v55, v223
    v_mfma_f32_16x16x32_bf16 v[68:71], a[196:199], a[100:103], v[68:71]
    ds_read_b128 a[68:71], v240 offset:1024
    v_mul_f32 v228, v228, v148
    v_mfma_f32_16x16x32_bf16 v[68:71], a[200:203], a[116:119], v[68:71]
    ds_read_b128 a[84:87], v240 offset:5120
    v_mul_f32 v229, v229, v149
    v_mfma_f32_16x16x32_bf16 v[68:71], a[204:207], a[132:135], v[68:71]
    ds_read_b128 a[72:75], v241 offset:0
    v_mul_f32 v230, v230, v150
    v_mfma_f32_16x16x32_bf16 v[72:75], a[196:199], a[104:107], v[72:75]
    ds_read_b128 a[88:91], v241 offset:4096
    v_mul_f32 v231, v231, v151
    v_mfma_f32_16x16x32_bf16 v[72:75], a[200:203], a[120:123], v[72:75]
    ds_read_b128 a[76:79], v241 offset:1024
    v_cvt_pk_bf16_f32 v238, v228, v229
    v_mfma_f32_16x16x32_bf16 v[72:75], a[204:207], a[136:139], v[72:75]
    ds_read_b128 a[92:95], v241 offset:5120
    v_cvt_pk_bf16_f32 v239, v230, v231
    v_mfma_f32_16x16x32_bf16 v[76:79], a[196:199], a[108:111], v[76:79]
    ds_write_b128 v242, v[236:239] offset:17408
    v_mfma_f32_16x16x32_bf16 v[76:79], a[200:203], a[124:127], v[76:79]
    buffer_load_dwordx4 a[196:199], off, s[72:75], s81 offset:2048 sc1
    v_mfma_f32_16x16x32_bf16 v[76:79], a[204:207], a[140:143], v[76:79]
    s_waitcnt vmcnt(17)
    v_add_f32 v224, v40, v216
    v_add_f32 v225, v41, v217
    v_mfma_f32_16x16x32_bf16 v[80:83], a[208:211], a[96:99], v[80:83]
    buffer_load_dwordx4 a[200:203], off, s[72:75], s81 offset:1024 sc1
    v_mfma_f32_16x16x32_bf16 v[80:83], a[212:215], a[112:115], v[80:83]
    v_add_f32 v226, v42, v218
    v_add_f32 v227, v43, v219
    v_mfma_f32_16x16x32_bf16 v[80:83], a[216:219], a[128:131], v[80:83]
    buffer_load_dwordx4 a[204:207], off, s[72:75], s81 offset:3072 sc1
    v_mfma_f32_16x16x32_bf16 v[84:87], a[208:211], a[100:103], v[84:87]
    v_mul_f32 v224, v224, v152
    v_mul_f32 v225, v225, v153
    v_mfma_f32_16x16x32_bf16 v[84:87], a[212:215], a[116:119], v[84:87]
    v_mul_f32 v226, v226, v154
    v_mul_f32 v227, v227, v155
    v_mfma_f32_16x16x32_bf16 v[84:87], a[216:219], a[132:135], v[84:87]
    v_cvt_pk_bf16_f32 v232, v224, v225
    v_cvt_pk_bf16_f32 v233, v226, v227
    v_mfma_f32_16x16x32_bf16 v[88:91], a[208:211], a[104:107], v[88:91]
    v_add_f32 v228, v56, v220
    v_add_f32 v229, v57, v221
    v_mfma_f32_16x16x32_bf16 v[88:91], a[212:215], a[120:123], v[88:91]
    s_add_u32 s81, s80, 360448
    v_add_f32 v230, v58, v222
    v_add_f32 v231, v59, v223
    v_mfma_f32_16x16x32_bf16 v[88:91], a[216:219], a[136:139], v[88:91]
    v_mul_f32 v228, v228, v156
    v_mul_f32 v229, v229, v157
    v_mfma_f32_16x16x32_bf16 v[92:95], a[208:211], a[108:111], v[92:95]
    v_mul_f32 v230, v230, v158
    v_mul_f32 v231, v231, v159
    v_mfma_f32_16x16x32_bf16 v[92:95], a[212:215], a[124:127], v[92:95]
    buffer_load_dwordx4 a[208:211], off, s[72:75], s81 offset:0 sc1
    v_mfma_f32_16x16x32_bf16 v[92:95], a[216:219], a[140:143], v[92:95]
    s_waitcnt vmcnt(17)
    v_cvt_pk_bf16_f32 v234, v228, v229
    v_cvt_pk_bf16_f32 v235, v230, v231
    v_mfma_f32_16x16x32_bf16 v[96:99], a[220:223], a[96:99], v[96:99]
    buffer_load_dwordx4 a[212:215], off, s[72:75], s81 offset:2048 sc1
    v_mfma_f32_16x16x32_bf16 v[96:99], a[224:227], a[112:115], v[96:99]
    ds_write_b128 v243, v[232:235] offset:16384
    v_mfma_f32_16x16x32_bf16 v[96:99], a[228:231], a[128:131], v[96:99]
    buffer_load_dwordx4 a[216:219], off, s[72:75], s81 offset:1024 sc1
    v_mfma_f32_16x16x32_bf16 v[100:103], a[220:223], a[100:103], v[100:103]
    ds_read_b128 a[96:99], v240 offset:8192
    v_add_f32 v224, v44, v216
    v_mfma_f32_16x16x32_bf16 v[100:103], a[224:227], a[116:119], v[100:103]
    buffer_load_dwordx4 a[220:223], off, s[72:75], s81 offset:3072 sc1
    v_mfma_f32_16x16x32_bf16 v[100:103], a[228:231], a[132:135], v[100:103]
    s_waitcnt vmcnt(18) lgkmcnt(9)
    ds_read_b128 a[112:115], v240 offset:12288
    v_add_f32 v225, v45, v217
    v_mfma_f32_16x16x32_bf16 v[0:3], a[144:147], a[64:67], v[0:3]
    s_add_u32 s81, s80, 364544
    ds_read_b128 a[100:103], v240 offset:9216
    v_add_f32 v226, v46, v218
    v_mfma_f32_16x16x32_bf16 v[0:3], a[148:151], a[80:83], v[0:3]
    s_waitcnt lgkmcnt(9)
    buffer_load_dwordx4 a[224:227], off, s[72:75], s81 offset:0 sc1
    v_mfma_f32_16x16x32_bf16 v[4:7], a[144:147], a[68:71], v[4:7]
    ds_read_b128 a[116:119], v240 offset:13312
    v_add_f32 v227, v47, v219
    v_mfma_f32_16x16x32_bf16 v[4:7], a[148:151], a[84:87], v[4:7]
    s_waitcnt lgkmcnt(8)
    buffer_load_dwordx4 a[228:231], off, s[72:75], s81 offset:2048 sc1
    v_mfma_f32_16x16x32_bf16 v[8:11], a[144:147], a[72:75], v[8:11]
    ds_read_b128 a[104:107], v241 offset:8192
    v_mul_f32 v224, v224, v160
    v_mfma_f32_16x16x32_bf16 v[8:11], a[148:151], a[88:91], v[8:11]
    s_waitcnt lgkmcnt(7)
    buffer_load_dwordx4 a[232:235], off, s[72:75], s81 offset:1024 sc1
    v_mfma_f32_16x16x32_bf16 v[12:15], a[144:147], a[76:79], v[12:15]
    ds_read_b128 a[120:123], v241 offset:12288
    v_mul_f32 v225, v225, v161
    v_mfma_f32_16x16x32_bf16 v[12:15], a[148:151], a[92:95], v[12:15]
    s_waitcnt vmcnt(19)
    buffer_load_dwordx4 a[144:147], off, s[72:75], s81 offset:3072 sc1
    v_mfma_f32_16x16x32_bf16 v[16:19], a[152:155], a[64:67], v[16:19]
    s_add_u32 s81, s80, 405504
    ds_read_b128 a[108:111], v241 offset:9216
    v_mul_f32 v226, v226, v162
    v_mfma_f32_16x16x32_bf16 v[16:19], a[156:159], a[80:83], v[16:19]
    buffer_load_dwordx4 a[148:151], off, s[72:75], s81 offset:0 sc1
    v_mfma_f32_16x16x32_bf16 v[20:23], a[152:155], a[68:71], v[20:23]
    ds_read_b128 a[124:127], v241 offset:13312
    v_mul_f32 v227, v227, v163
    v_mfma_f32_16x16x32_bf16 v[20:23], a[156:159], a[84:87], v[20:23]
    v_cvt_pk_bf16_f32 v236, v224, v225
    v_cvt_pk_bf16_f32 v237, v226, v227
    v_mfma_f32_16x16x32_bf16 v[24:27], a[152:155], a[72:75], v[24:27]
    v_add_f32 v228, v60, v220
    v_add_f32 v229, v61, v221
    v_mfma_f32_16x16x32_bf16 v[24:27], a[156:159], a[88:91], v[24:27]
    v_add_f32 v230, v62, v222
    v_add_f32 v231, v63, v223
    v_mfma_f32_16x16x32_bf16 v[28:31], a[152:155], a[76:79], v[28:31]
    ds_read_b128 v[216:219], v251 offset:2048
    v_mul_f32 v228, v228, v164
    v_mfma_f32_16x16x32_bf16 v[28:31], a[156:159], a[92:95], v[28:31]
    s_waitcnt vmcnt(19) lgkmcnt(7)
    buffer_load_dwordx4 a[152:155], off, s[72:75], s81 offset:2048 sc1
    v_mfma_f32_16x16x32_bf16 v[0:3], a[160:163], a[96:99], v[0:3]
    v_mul_f32 v229, v229, v165
    v_mul_f32 v230, v230, v166
    v_mfma_f32_16x16x32_bf16 v[0:3], a[164:167], a[112:115], v[0:3]
    s_waitcnt lgkmcnt(5)
    buffer_load_dwordx4 a[156:159], off, s[72:75], s81 offset:1024 sc1
    v_mfma_f32_16x16x32_bf16 v[4:7], a[160:163], a[100:103], v[4:7]
    v_mul_f32 v231, v231, v167
    v_cvt_pk_bf16_f32 v238, v228, v229
    v_mfma_f32_16x16x32_bf16 v[4:7], a[164:167], a[116:119], v[4:7]
    s_waitcnt lgkmcnt(3)
    v_cvt_pk_bf16_f32 v239, v230, v231
    v_add_f32 v224, v64, v208
    v_mfma_f32_16x16x32_bf16 v[8:11], a[160:163], a[104:107], v[8:11]
    ds_write_b128 v243, v[236:239] offset:17408
    v_mfma_f32_16x16x32_bf16 v[8:11], a[164:167], a[120:123], v[8:11]
    s_waitcnt lgkmcnt(2)
    v_add_f32 v225, v65, v209
    v_add_f32 v226, v66, v210
    v_mfma_f32_16x16x32_bf16 v[12:15], a[160:163], a[108:111], v[12:15]
    v_add_f32 v227, v67, v211
    v_mul_f32 v224, v224, v168
    v_mfma_f32_16x16x32_bf16 v[12:15], a[164:167], a[124:127], v[12:15]
    s_waitcnt vmcnt(19)
    buffer_load_dwordx4 a[160:163], off, s[72:75], s81 offset:3072 sc1
    v_mfma_f32_16x16x32_bf16 v[16:19], a[168:171], a[96:99], v[16:19]
    s_add_u32 s82, s80, 352256
    v_mul_f32 v225, v225, v169
    v_mul_f32 v226, v226, v170
    v_mfma_f32_16x16x32_bf16 v[16:19], a[172:175], a[112:115], v[16:19]
    buffer_load_dwordx4 a[164:167], off, s[76:79], s82 offset:0
    v_mfma_f32_16x16x32_bf16 v[20:23], a[168:171], a[100:103], v[20:23]
    v_mul_f32 v227, v227, v171
    v_cvt_pk_bf16_f32 v232, v224, v225
    v_mfma_f32_16x16x32_bf16 v[20:23], a[172:175], a[116:119], v[20:23]
    v_cvt_pk_bf16_f32 v233, v226, v227
    v_add_f32 v228, v80, v212
    v_mfma_f32_16x16x32_bf16 v[24:27], a[168:171], a[104:107], v[24:27]
    v_add_f32 v229, v81, v213
    v_add_f32 v230, v82, v214
    v_mfma_f32_16x16x32_bf16 v[24:27], a[172:175], a[120:123], v[24:27]
    v_add_f32 v231, v83, v215
    v_mul_f32 v228, v228, v172
    v_mfma_f32_16x16x32_bf16 v[28:31], a[168:171], a[108:111], v[28:31]
    v_mul_f32 v229, v229, v173
    v_mul_f32 v230, v230, v174
    v_mfma_f32_16x16x32_bf16 v[28:31], a[172:175], a[124:127], v[28:31]
    s_waitcnt vmcnt(19)
    buffer_load_dwordx4 a[168:171], off, s[76:79], s82 offset:1024
    v_mfma_f32_16x16x32_bf16 v[32:35], a[176:179], a[64:67], v[32:35]
    s_add_u32 s81, s80, 409600
    v_mul_f32 v231, v231, v175
    v_cvt_pk_bf16_f32 v234, v228, v229
    v_mfma_f32_16x16x32_bf16 v[32:35], a[180:183], a[80:83], v[32:35]
    buffer_load_dwordx4 a[172:175], off, s[72:75], s81 offset:0 sc1
    v_mfma_f32_16x16x32_bf16 v[36:39], a[176:179], a[68:71], v[36:39]
    v_cvt_pk_bf16_f32 v235, v230, v231
    v_add_f32 v224, v68, v208
    v_mfma_f32_16x16x32_bf16 v[36:39], a[180:183], a[84:87], v[36:39]
    ds_write_b128 v242, v[232:235] offset:32768
    v_mfma_f32_16x16x32_bf16 v[40:43], a[176:179], a[72:75], v[40:43]
    v_add_f32 v225, v69, v209
    v_add_f32 v226, v70, v210
    v_mfma_f32_16x16x32_bf16 v[40:43], a[180:183], a[88:91], v[40:43]
    v_add_f32 v227, v71, v211
    v_mul_f32 v224, v224, v176
    v_mfma_f32_16x16x32_bf16 v[44:47], a[176:179], a[76:79], v[44:47]
    v_mul_f32 v225, v225, v177
    v_mul_f32 v226, v226, v178
    v_mfma_f32_16x16x32_bf16 v[44:47], a[180:183], a[92:95], v[44:47]
    s_waitcnt vmcnt(19)
    buffer_load_dwordx4 a[176:179], off, s[72:75], s81 offset:2048 sc1
    v_mfma_f32_16x16x32_bf16 v[48:51], a[184:187], a[64:67], v[48:51]
    v_mul_f32 v227, v227, v179
    v_cvt_pk_bf16_f32 v236, v224, v225
    v_mfma_f32_16x16x32_bf16 v[48:51], a[188:191], a[80:83], v[48:51]
    buffer_load_dwordx4 a[180:183], off, s[72:75], s81 offset:1024 sc1
    v_mfma_f32_16x16x32_bf16 v[52:55], a[184:187], a[68:71], v[52:55]
    v_cvt_pk_bf16_f32 v237, v226, v227
    v_add_f32 v228, v84, v212
    v_mfma_f32_16x16x32_bf16 v[52:55], a[188:191], a[84:87], v[52:55]
    v_add_f32 v229, v85, v213
    v_add_f32 v230, v86, v214
    v_mfma_f32_16x16x32_bf16 v[56:59], a[184:187], a[72:75], v[56:59]
    v_add_f32 v231, v87, v215
    v_mul_f32 v228, v228, v180
    v_mfma_f32_16x16x32_bf16 v[56:59], a[188:191], a[88:91], v[56:59]
    v_mul_f32 v229, v229, v181
    v_mul_f32 v230, v230, v182
    v_mfma_f32_16x16x32_bf16 v[60:63], a[184:187], a[76:79], v[60:63]
    v_mul_f32 v231, v231, v183
    v_cvt_pk_bf16_f32 v238, v228, v229
    v_mfma_f32_16x16x32_bf16 v[60:63], a[188:191], a[92:95], v[60:63]
    s_waitcnt vmcnt(19)
    buffer_load_dwordx4 a[184:187], off, s[72:75], s81 offset:3072 sc1
    v_mfma_f32_16x16x32_bf16 v[32:35], a[192:195], a[96:99], v[32:35]
    s_waitcnt lgkmcnt(1)
    s_barrier
    v_mfma_f32_16x16x32_bf16 v[32:35], a[196:199], a[112:115], v[32:35]
    buffer_load_dwordx4 a[188:191], off, s[76:79], s82 offset:2048
    v_mfma_f32_16x16x32_bf16 v[36:39], a[192:195], a[100:103], v[36:39]
    ds_read_b128 a[0:3], v240 offset:16384
    v_cvt_pk_bf16_f32 v239, v230, v231
    v_mfma_f32_16x16x32_bf16 v[36:39], a[196:199], a[116:119], v[36:39]
    ds_write_b128 v242, v[236:239] offset:33792
    v_mfma_f32_16x16x32_bf16 v[40:43], a[192:195], a[104:107], v[40:43]
    ds_read_b128 a[16:19], v240 offset:20480
    v_add_f32 v224, v72, v208
    v_mfma_f32_16x16x32_bf16 v[40:43], a[196:199], a[120:123], v[40:43]
    ds_read_b128 a[4:7], v240 offset:17408
    v_add_f32 v225, v73, v209
    v_mfma_f32_16x16x32_bf16 v[44:47], a[192:195], a[108:111], v[44:47]
    ds_read_b128 a[20:23], v240 offset:21504
    v_add_f32 v226, v74, v210
    v_mfma_f32_16x16x32_bf16 v[44:47], a[196:199], a[124:127], v[44:47]
    s_waitcnt vmcnt(19)
    buffer_load_dwordx4 a[192:195], off, s[76:79], s82 offset:3072
    v_mfma_f32_16x16x32_bf16 v[48:51], a[200:203], a[96:99], v[48:51]
    s_add_u32 s81, s80, 387072
    ds_read_b128 a[8:11], v241 offset:16384
    v_add_f32 v227, v75, v211
    v_mfma_f32_16x16x32_bf16 v[48:51], a[204:207], a[112:115], v[48:51]
    buffer_load_dwordx4 a[196:199], off, s[72:75], s81 offset:0 sc1
    v_mfma_f32_16x16x32_bf16 v[52:55], a[200:203], a[100:103], v[52:55]
    ds_read_b128 a[24:27], v241 offset:20480
    v_mul_f32 v224, v224, v184
    v_mfma_f32_16x16x32_bf16 v[52:55], a[204:207], a[116:119], v[52:55]
    ds_read_b128 a[12:15], v241 offset:17408
    v_mul_f32 v225, v225, v185
    v_mfma_f32_16x16x32_bf16 v[56:59], a[200:203], a[104:107], v[56:59]
    ds_read_b128 a[28:31], v241 offset:21504
    v_mul_f32 v226, v226, v186
    v_mfma_f32_16x16x32_bf16 v[56:59], a[204:207], a[120:123], v[56:59]
    ds_read_b128 a[32:35], v240 offset:24576
    v_mul_f32 v227, v227, v187
    v_mfma_f32_16x16x32_bf16 v[60:63], a[200:203], a[108:111], v[60:63]
    ds_read_b128 a[48:51], v240 offset:28672
    v_cvt_pk_bf16_f32 v232, v224, v225
    v_mfma_f32_16x16x32_bf16 v[60:63], a[204:207], a[124:127], v[60:63]
    s_waitcnt vmcnt(19) lgkmcnt(8)
    buffer_load_dwordx4 a[200:203], off, s[72:75], s81 offset:2048 sc1
    v_mfma_f32_16x16x32_bf16 v[0:3], a[208:211], a[0:3], v[0:3]
    ds_read_b128 a[36:39], v240 offset:25600
    v_cvt_pk_bf16_f32 v233, v226, v227
    v_mfma_f32_16x16x32_bf16 v[0:3], a[212:215], a[16:19], v[0:3]
    s_waitcnt lgkmcnt(7)
    buffer_load_dwordx4 a[204:207], off, s[72:75], s81 offset:1024 sc1
    v_mfma_f32_16x16x32_bf16 v[4:7], a[208:211], a[4:7], v[4:7]
    ds_read_b128 a[52:55], v240 offset:29696
    v_add_f32 v228, v88, v212
    v_mfma_f32_16x16x32_bf16 v[4:7], a[212:215], a[20:23], v[4:7]
    s_waitcnt lgkmcnt(6)
    ds_read_b128 a[40:43], v241 offset:24576
    v_add_f32 v229, v89, v213
    v_mfma_f32_16x16x32_bf16 v[8:11], a[208:211], a[8:11], v[8:11]
    ds_read_b128 a[56:59], v241 offset:28672
    v_add_f32 v230, v90, v214
    v_mfma_f32_16x16x32_bf16 v[8:11], a[212:215], a[24:27], v[8:11]
    s_waitcnt lgkmcnt(6)
    ds_read_b128 a[44:47], v241 offset:25600
    v_add_f32 v231, v91, v215
    v_mfma_f32_16x16x32_bf16 v[12:15], a[208:211], a[12:15], v[12:15]
    ds_read_b128 a[60:63], v241 offset:29696
    v_mul_f32 v228, v228, v188
    v_mfma_f32_16x16x32_bf16 v[12:15], a[212:215], a[28:31], v[12:15]
    s_waitcnt vmcnt(19)
    buffer_load_dwordx4 a[208:211], off, s[72:75], s81 offset:3072 sc1
    v_mfma_f32_16x16x32_bf16 v[16:19], a[216:219], a[0:3], v[16:19]
    s_add_u32 s81, s80, 391168
    v_mul_f32 v229, v229, v189
    v_mul_f32 v230, v230, v190
    v_mfma_f32_16x16x32_bf16 v[16:19], a[220:223], a[16:19], v[16:19]
    buffer_load_dwordx4 a[212:215], off, s[72:75], s81 offset:0 sc1
    v_mfma_f32_16x16x32_bf16 v[20:23], a[216:219], a[4:7], v[20:23]
    v_mul_f32 v231, v231, v191
    v_cvt_pk_bf16_f32 v234, v228, v229
    v_mfma_f32_16x16x32_bf16 v[20:23], a[220:223], a[20:23], v[20:23]
    v_cvt_pk_bf16_f32 v235, v230, v231
    v_add_f32 v224, v76, v208
    v_mfma_f32_16x16x32_bf16 v[24:27], a[216:219], a[8:11], v[24:27]
    ds_write_b128 v243, v[232:235] offset:32768
    v_mfma_f32_16x16x32_bf16 v[24:27], a[220:223], a[24:27], v[24:27]
    v_add_f32 v225, v77, v209
    v_add_f32 v226, v78, v210
    v_mfma_f32_16x16x32_bf16 v[28:31], a[216:219], a[12:15], v[28:31]
    v_add_f32 v227, v79, v211
    v_mul_f32 v224, v224, v192
    v_mfma_f32_16x16x32_bf16 v[28:31], a[220:223], a[28:31], v[28:31]
    s_waitcnt vmcnt(19) lgkmcnt(7)
    buffer_load_dwordx4 a[216:219], off, s[72:75], s81 offset:2048 sc1
    v_mfma_f32_16x16x32_bf16 v[0:3], a[224:227], a[32:35], v[0:3]
    v_mul_f32 v225, v225, v193
    v_mul_f32 v226, v226, v194
    v_mfma_f32_16x16x32_bf16 v[0:3], a[228:231], a[48:51], v[0:3]
    s_waitcnt lgkmcnt(5)
    buffer_load_dwordx4 a[220:223], off, s[72:75], s81 offset:1024 sc1
    v_mfma_f32_16x16x32_bf16 v[4:7], a[224:227], a[36:39], v[4:7]
    v_mul_f32 v227, v227, v195
    v_cvt_pk_bf16_f32 v236, v224, v225
    v_mfma_f32_16x16x32_bf16 v[4:7], a[228:231], a[52:55], v[4:7]
    s_waitcnt lgkmcnt(3)
    v_cvt_pk_bf16_f32 v237, v226, v227
    v_add_f32 v228, v92, v212
    v_mfma_f32_16x16x32_bf16 v[8:11], a[224:227], a[40:43], v[8:11]
    v_add_f32 v229, v93, v213
    v_add_f32 v230, v94, v214
    v_mfma_f32_16x16x32_bf16 v[8:11], a[228:231], a[56:59], v[8:11]
    s_waitcnt lgkmcnt(1)
    v_add_f32 v231, v95, v215
    v_mul_f32 v228, v228, v196
    v_mfma_f32_16x16x32_bf16 v[12:15], a[224:227], a[44:47], v[12:15]
    v_mul_f32 v229, v229, v197
    v_mul_f32 v230, v230, v198
    v_mfma_f32_16x16x32_bf16 v[12:15], a[228:231], a[60:63], v[12:15]
    s_waitcnt vmcnt(19)
    buffer_load_dwordx4 a[224:227], off, s[72:75], s81 offset:3072 sc1
    v_mfma_f32_16x16x32_bf16 v[16:19], a[232:235], a[32:35], v[16:19]
    s_add_u32 s81, s80, 368640
    v_mul_f32 v231, v231, v199
    v_cvt_pk_bf16_f32 v238, v228, v229
    v_mfma_f32_16x16x32_bf16 v[16:19], a[144:147], a[48:51], v[16:19]
    buffer_load_dwordx4 a[228:231], off, s[72:75], s81 offset:0 sc1
    v_mfma_f32_16x16x32_bf16 v[20:23], a[232:235], a[36:39], v[20:23]
    s_add_u32 s36, s22, 704512
    v_cvt_pk_bf16_f32 v239, v230, v231
    v_add_f32 v224, v96, v216
    v_mfma_f32_16x16x32_bf16 v[20:23], a[144:147], a[52:55], v[20:23]
    s_addc_u32 s37, s23, 0
    ds_write_b128 v243, v[236:239] offset:33792
    v_mfma_f32_16x16x32_bf16 v[24:27], a[232:235], a[40:43], v[24:27]
    s_bfe_i32 s100, s0, 0x10000
    v_add_f32 v225, v97, v217
    v_add_f32 v226, v98, v218
    v_mfma_f32_16x16x32_bf16 v[24:27], a[144:147], a[56:59], v[24:27]
    s_and_b32 s101, s100, 0x7ff
    v_add_f32 v227, v99, v219
    v_mul_f32 v224, v224, v200
    v_mfma_f32_16x16x32_bf16 v[28:31], a[232:235], a[44:47], v[28:31]
    s_lshr_b32 s0, s0, 1
    v_mul_f32 v225, v225, v201
    v_mul_f32 v226, v226, v202
    v_mfma_f32_16x16x32_bf16 v[28:31], a[144:147], a[60:63], v[28:31]
    s_waitcnt vmcnt(19)
    v_mul_f32 v227, v227, v203
    v_cvt_pk_bf16_f32 v232, v224, v225
    v_mfma_f32_16x16x32_bf16 v[64:67], a[148:151], a[64:67], v[64:67]
    s_mov_b64 exec, s[100:101]
    s_cbranch_execz L_skip_pf3
    global_load_dword v253, v252, s[36:37] sc1
L_skip_pf3:
    s_mov_b64 exec, -1
    v_mfma_f32_16x16x32_bf16 v[64:67], a[152:155], a[80:83], v[64:67]
    v_cvt_pk_bf16_f32 v233, v226, v227
    v_add_f32 v224, v100, v216
    v_mfma_f32_16x16x32_bf16 v[68:71], a[148:151], a[68:71], v[68:71]
    buffer_load_dwordx4 a[232:235], off, s[72:75], s81 offset:2048 sc1
    v_mfma_f32_16x16x32_bf16 v[68:71], a[152:155], a[84:87], v[68:71]
    ds_write_b64 v244, v[232:233] offset:0
    v_mfma_f32_16x16x32_bf16 v[72:75], a[148:151], a[72:75], v[72:75]
    buffer_load_dwordx4 a[144:147], off, s[72:75], s81 offset:1024 sc1
    v_mfma_f32_16x16x32_bf16 v[72:75], a[152:155], a[88:91], v[72:75]
    v_add_f32 v225, v101, v217
    v_add_f32 v226, v102, v218
    v_mfma_f32_16x16x32_bf16 v[76:79], a[148:151], a[76:79], v[76:79]
    v_add_f32 v227, v103, v219
    v_mul_f32 v224, v224, v204
    v_mfma_f32_16x16x32_bf16 v[76:79], a[152:155], a[92:95], v[76:79]
    s_waitcnt vmcnt(19)
    buffer_load_dwordx4 a[148:151], off, s[72:75], s81 offset:3072 sc1
    v_mfma_f32_16x16x32_bf16 v[80:83], a[156:159], a[64:67], v[80:83]
    s_add_u32 s81, s80, 372736
    v_mul_f32 v225, v225, v205
    v_mul_f32 v226, v226, v206
    v_mfma_f32_16x16x32_bf16 v[80:83], a[160:163], a[80:83], v[80:83]
    buffer_load_dwordx4 a[152:155], off, s[72:75], s81 offset:0 sc1
    v_mfma_f32_16x16x32_bf16 v[84:87], a[156:159], a[68:71], v[84:87]
    v_mul_f32 v227, v227, v207
    v_cvt_pk_bf16_f32 v236, v224, v225
    v_mfma_f32_16x16x32_bf16 v[84:87], a[160:163], a[84:87], v[84:87]
    v_cvt_pk_bf16_f32 v237, v226, v227
    v_mfma_f32_16x16x32_bf16 v[88:91], a[156:159], a[72:75], v[88:91]
    ds_write_b64 v244, v[236:237] offset:1024
    v_mfma_f32_16x16x32_bf16 v[88:91], a[160:163], a[88:91], v[88:91]
    v_mfma_f32_16x16x32_bf16 v[92:95], a[156:159], a[76:79], v[92:95]
    v_mfma_f32_16x16x32_bf16 v[92:95], a[160:163], a[92:95], v[92:95]
    s_waitcnt vmcnt(19)
    buffer_load_dwordx4 a[156:159], off, s[72:75], s81 offset:2048 sc1
    v_mfma_f32_16x16x32_bf16 v[96:99], a[164:167], a[64:67], v[96:99]
    s_add_u32 s81, s80, 376832
    v_mfma_f32_16x16x32_bf16 v[96:99], a[168:171], a[80:83], v[96:99]
    buffer_load_dwordx4 a[160:163], off, s[72:75], s81 offset:0 sc1
    v_mfma_f32_16x16x32_bf16 v[100:103], a[164:167], a[68:71], v[100:103]
    s_add_u32 s81, s80, 372736
    v_mfma_f32_16x16x32_bf16 v[100:103], a[168:171], a[84:87], v[100:103]
    s_waitcnt vmcnt(19)
    buffer_load_dwordx4 a[164:167], off, s[72:75], s81 offset:1024 sc1
    v_mfma_f32_16x16x32_bf16 v[64:67], a[172:175], a[96:99], v[64:67]
    v_mfma_f32_16x16x32_bf16 v[64:67], a[176:179], a[112:115], v[64:67]
    buffer_load_dwordx4 a[168:171], off, s[72:75], s81 offset:3072 sc1
    v_mfma_f32_16x16x32_bf16 v[68:71], a[172:175], a[100:103], v[68:71]
    v_mfma_f32_16x16x32_bf16 v[68:71], a[176:179], a[116:119], v[68:71]
    v_mfma_f32_16x16x32_bf16 v[72:75], a[172:175], a[104:107], v[72:75]
    s_add_u32 s81, s80, 376832
    v_mfma_f32_16x16x32_bf16 v[72:75], a[176:179], a[120:123], v[72:75]
    v_mfma_f32_16x16x32_bf16 v[76:79], a[172:175], a[108:111], v[76:79]
    v_mfma_f32_16x16x32_bf16 v[76:79], a[176:179], a[124:127], v[76:79]
    s_waitcnt vmcnt(19)
    buffer_load_dwordx4 a[172:175], off, s[72:75], s81 offset:1024 sc1
    v_mfma_f32_16x16x32_bf16 v[80:83], a[180:183], a[96:99], v[80:83]
    s_add_u32 s81, s80, 413696
    v_mfma_f32_16x16x32_bf16 v[80:83], a[184:187], a[112:115], v[80:83]
    buffer_load_dwordx4 a[176:179], off, s[72:75], s81 offset:0 sc1
    v_mfma_f32_16x16x32_bf16 v[84:87], a[180:183], a[100:103], v[84:87]
    v_mfma_f32_16x16x32_bf16 v[84:87], a[184:187], a[116:119], v[84:87]
    v_mfma_f32_16x16x32_bf16 v[88:91], a[180:183], a[104:107], v[88:91]
    v_mfma_f32_16x16x32_bf16 v[88:91], a[184:187], a[120:123], v[88:91]
    v_mfma_f32_16x16x32_bf16 v[92:95], a[180:183], a[108:111], v[92:95]
    v_mfma_f32_16x16x32_bf16 v[92:95], a[184:187], a[124:127], v[92:95]
    s_waitcnt vmcnt(19)
    buffer_load_dwordx4 a[180:183], off, s[72:75], s81 offset:2048 sc1
    v_mfma_f32_16x16x32_bf16 v[96:99], a[188:191], a[96:99], v[96:99]
    v_mfma_f32_16x16x32_bf16 v[96:99], a[192:195], a[112:115], v[96:99]
    s_add_u32 s22, s22, 352256
    s_addc_u32 s23, s23, 0
    s_add_u32 s80, s80, 352256
    v_add_u32 v245, 2048, v245
    v_add_u32 v251, 2048, v251
    s_sub_u32 s17, s17, 1
    s_cmp_lg_u32 s17, 0
    s_cbranch_scc1 L_loop
    v_mfma_f32_16x16x32_bf16 v[100:103], a[188:191], a[100:103], v[100:103]
    buffer_load_dwordx4 a[184:187], off, s[72:75], s81 offset:1024 sc1
    v_mfma_f32_16x16x32_bf16 v[100:103], a[192:195], a[116:119], v[100:103]
    s_waitcnt vmcnt(15)
    v_add_u32 v254, s26, v246
    s_add_u32 s18, s22, 47104
    v_mfma_f32_16x16x32_bf16 v[32:35], a[196:199], a[0:3], v[32:35]
    s_waitcnt lgkmcnt(0)
    s_barrier
    v_mfma_f32_16x16x32_bf16 v[32:35], a[200:203], a[16:19], v[32:35]
    s_addc_u32 s19, s23, 0
    ds_read_b128 a[64:67], v240 offset:32768
    v_mfma_f32_16x16x32_bf16 v[32:35], a[212:215], a[32:35], v[32:35]
    global_load_dwordx4 a[236:239], v246, s[18:19] offset:-4096 sc1
    ds_read_b128 a[80:83], v240 offset:36864
    v_mfma_f32_16x16x32_bf16 v[32:35], a[216:219], a[48:51], v[32:35]
    ds_read_b128 a[96:99], v240 offset:40960
    v_mfma_f32_16x16x32_bf16 v[36:39], a[196:199], a[4:7], v[36:39]
    global_load_dwordx4 a[240:243], v246, s[18:19] offset:-2048 sc1
    ds_read_b128 a[112:115], v240 offset:45056
    v_mfma_f32_16x16x32_bf16 v[36:39], a[200:203], a[20:23], v[36:39]
    ds_read_b128 a[128:131], v240 offset:49152
    v_mfma_f32_16x16x32_bf16 v[36:39], a[212:215], a[36:39], v[36:39]
    global_load_dwordx4 a[188:191], v246, s[18:19] offset:0 sc1
    ds_read_b128 a[68:71], v240 offset:33792
    v_mfma_f32_16x16x32_bf16 v[36:39], a[216:219], a[52:55], v[36:39]
    ds_read_b128 a[84:87], v240 offset:37888
    v_mfma_f32_16x16x32_bf16 v[40:43], a[196:199], a[8:11], v[40:43]
    global_load_dwordx4 a[192:195], v246, s[18:19] offset:2048 sc1
    ds_read_b128 a[100:103], v240 offset:41984
    v_mfma_f32_16x16x32_bf16 v[40:43], a[200:203], a[24:27], v[40:43]
    ds_read_b128 a[116:119], v240 offset:46080
    v_mfma_f32_16x16x32_bf16 v[40:43], a[212:215], a[40:43], v[40:43]
    s_add_u32 s18, s22, 55296
    ds_read_b128 v[208:211], v245 offset:2048
    s_addc_u32 s19, s23, 0
    v_mfma_f32_16x16x32_bf16 v[40:43], a[216:219], a[56:59], v[40:43]
    ds_read_b128 a[132:135], v240 offset:50176
    v_mfma_f32_16x16x32_bf16 v[44:47], a[196:199], a[12:15], v[44:47]
    ds_read_b128 a[72:75], v241 offset:32768
    v_mfma_f32_16x16x32_bf16 v[44:47], a[200:203], a[28:31], v[44:47]
    global_load_dwordx4 a[196:199], v246, s[18:19] offset:-4096 sc1
    ds_read_b128 a[88:91], v241 offset:36864
    v_mfma_f32_16x16x32_bf16 v[44:47], a[212:215], a[44:47], v[44:47]
    s_add_u32 s18, s22, 48128
    ds_read_b128 a[104:107], v241 offset:40960
    s_addc_u32 s19, s23, 0
    v_mfma_f32_16x16x32_bf16 v[44:47], a[216:219], a[60:63], v[44:47]
    s_waitcnt vmcnt(12) lgkmcnt(10)
    global_load_dwordx4 a[200:203], v246, s[18:19] offset:-4096 sc1
    ds_read_b128 a[120:123], v241 offset:45056
    v_mfma_f32_16x16x32_bf16 v[0:3], a[228:231], a[64:67], v[0:3]
    ds_read_b128 a[136:139], v241 offset:49152
    v_mfma_f32_16x16x32_bf16 v[0:3], a[232:235], a[80:83], v[0:3]
    global_load_dwordx4 a[212:215], v246, s[18:19] offset:-2048 sc1
    ds_read_b128 a[76:79], v241 offset:33792
    v_mfma_f32_16x16x32_bf16 v[0:3], a[152:155], a[96:99], v[0:3]
    ds_read_b128 a[92:95], v241 offset:37888
    v_mfma_f32_16x16x32_bf16 v[0:3], a[156:159], a[112:115], v[0:3]
    s_waitcnt vmcnt(13) lgkmcnt(13)
    global_load_dwordx4 a[216:219], v246, s[18:19] offset:0 sc1
    ds_read_b128 a[108:111], v241 offset:41984
    v_mfma_f32_16x16x32_bf16 v[0:3], a[160:163], a[128:131], v[0:3]
    s_waitcnt lgkmcnt(10)
    ds_read_b128 a[124:127], v241 offset:46080
    v_mfma_f32_16x16x32_bf16 v[4:7], a[228:231], a[68:71], v[4:7]
    ds_read_b128 a[140:143], v241 offset:50176
    v_mfma_f32_16x16x32_bf16 v[4:7], a[232:235], a[84:87], v[4:7]
    v_mfma_f32_16x16x32_bf16 v[4:7], a[152:155], a[100:103], v[4:7]
    v_mfma_f32_16x16x32_bf16 v[4:7], a[156:159], a[116:119], v[4:7]
    s_waitcnt lgkmcnt(10)
    v_mfma_f32_16x16x32_bf16 v[4:7], a[160:163], a[132:135], v[4:7]
    s_waitcnt lgkmcnt(6)
    v_mfma_f32_16x16x32_bf16 v[8:11], a[228:231], a[72:75], v[8:11]
    v_mfma_f32_16x16x32_bf16 v[8:11], a[232:235], a[88:91], v[8:11]
    v_mfma_f32_16x16x32_bf16 v[8:11], a[152:155], a[104:107], v[8:11]
    ds_read_b128 v[212:215], v245 offset:2064
    v_add_f32 v224, v0, v208
    v_mfma_f32_16x16x32_bf16 v[8:11], a[156:159], a[120:123], v[8:11]
    s_waitcnt lgkmcnt(6)
    v_add_f32 v225, v1, v209
    v_add_f32 v226, v2, v210
    v_mfma_f32_16x16x32_bf16 v[8:11], a[160:163], a[136:139], v[8:11]
    s_waitcnt lgkmcnt(2)
    v_add_f32 v227, v3, v211
    v_mul_f32 v224, v224, v104
    v_mfma_f32_16x16x32_bf16 v[12:15], a[228:231], a[76:79], v[12:15]
    v_mul_f32 v225, v225, v105
    v_mul_f32 v226, v226, v106
    v_mfma_f32_16x16x32_bf16 v[12:15], a[232:235], a[92:95], v[12:15]
    global_load_dwordx4 a[228:231], v246, s[18:19] offset:2048 sc1
    v_mul_f32 v227, v227, v107
    v_mfma_f32_16x16x32_bf16 v[12:15], a[152:155], a[108:111], v[12:15]
    s_add_u32 s18, s22, 56320
    v_cvt_pk_bf16_f32 v104, v224, v225
    v_cvt_pk_bf16_f32 v105, v226, v227
    v_mfma_f32_16x16x32_bf16 v[12:15], a[156:159], a[124:127], v[12:15]
    s_waitcnt lgkmcnt(1)
    v_add_f32 v228, v4, v208
    v_add_f32 v229, v5, v209
    v_mfma_f32_16x16x32_bf16 v[12:15], a[160:163], a[140:143], v[12:15]
    s_waitcnt vmcnt(13)
    v_add_f32 v230, v6, v210
    v_add_f32 v231, v7, v211
    v_mfma_f32_16x16x32_bf16 v[16:19], a[144:147], a[64:67], v[16:19]
    s_addc_u32 s19, s23, 0
    v_mul_f32 v228, v228, v112
    v_mul_f32 v229, v229, v113
    v_mfma_f32_16x16x32_bf16 v[16:19], a[148:151], a[80:83], v[16:19]
    global_load_dwordx4 a[232:235], v246, s[18:19] offset:-4096 sc1
    v_mul_f32 v230, v230, v114
    v_mfma_f32_16x16x32_bf16 v[16:19], a[164:167], a[96:99], v[16:19]
    s_add_u32 s20, s22, 8192
    v_mul_f32 v231, v231, v115
    v_cvt_pk_bf16_f32 v112, v228, v229
    v_mfma_f32_16x16x32_bf16 v[16:19], a[168:171], a[112:115], v[16:19]
    s_waitcnt vmcnt(13)
    v_cvt_pk_bf16_f32 v113, v230, v231
    v_add_f32 v224, v8, v208
    v_mfma_f32_16x16x32_bf16 v[16:19], a[172:175], a[128:131], v[16:19]
    s_addc_u32 s21, s23, 0
    v_add_f32 v225, v9, v209
    v_add_f32 v226, v10, v210
    v_mfma_f32_16x16x32_bf16 v[20:23], a[144:147], a[68:71], v[20:23]
    global_load_dwordx4 a[152:155], v247, s[20:21] offset:-4096
    v_add_f32 v227, v11, v211
    v_mfma_f32_16x16x32_bf16 v[20:23], a[148:151], a[84:87], v[20:23]
    v_mul_f32 v224, v224, v120
    v_mul_f32 v225, v225, v121
    v_mfma_f32_16x16x32_bf16 v[20:23], a[164:167], a[100:103], v[20:23]
    global_load_dwordx4 a[156:159], v247, s[20:21] offset:-3072
    v_mul_f32 v226, v226, v122
    v_mfma_f32_16x16x32_bf16 v[20:23], a[168:171], a[116:119], v[20:23]
    v_mul_f32 v227, v227, v123
    v_cvt_pk_bf16_f32 v120, v224, v225
    v_mfma_f32_16x16x32_bf16 v[20:23], a[172:175], a[132:135], v[20:23]
    global_load_dwordx4 a[160:163], v247, s[20:21] offset:-2048
    v_cvt_pk_bf16_f32 v121, v226, v227
    v_mfma_f32_16x16x32_bf16 v[24:27], a[144:147], a[72:75], v[24:27]
    v_add_f32 v228, v12, v208
    v_add_f32 v229, v13, v209
    v_mfma_f32_16x16x32_bf16 v[24:27], a[148:151], a[88:91], v[24:27]
    v_add_f32 v230, v14, v210
    v_add_f32 v231, v15, v211
    v_mfma_f32_16x16x32_bf16 v[24:27], a[164:167], a[104:107], v[24:27]
    ds_read_b128 v[216:219], v245 offset:2560
    v_mul_f32 v228, v228, v128
    v_mfma_f32_16x16x32_bf16 v[24:27], a[168:171], a[120:123], v[24:27]
    v_mul_f32 v229, v229, v129
    v_mul_f32 v230, v230, v130
    v_mfma_f32_16x16x32_bf16 v[24:27], a[172:175], a[136:139], v[24:27]
    v_mul_f32 v231, v231, v131
    v_cvt_pk_bf16_f32 v128, v228, v229
    v_mfma_f32_16x16x32_bf16 v[28:31], a[144:147], a[76:79], v[28:31]
    s_waitcnt lgkmcnt(1)
    v_cvt_pk_bf16_f32 v129, v230, v231
    v_add_f32 v224, v16, v212
    v_mfma_f32_16x16x32_bf16 v[28:31], a[148:151], a[92:95], v[28:31]
    global_load_dwordx4 a[144:147], v247, s[20:21] offset:-1024
    v_add_f32 v225, v17, v213
    v_mfma_f32_16x16x32_bf16 v[28:31], a[164:167], a[108:111], v[28:31]
    v_add_f32 v226, v18, v214
    v_add_f32 v227, v19, v215
    v_mfma_f32_16x16x32_bf16 v[28:31], a[168:171], a[124:127], v[28:31]
    global_load_dwordx4 a[148:151], v247, s[20:21] offset:0
    v_mul_f32 v224, v224, v108
    v_mfma_f32_16x16x32_bf16 v[28:31], a[172:175], a[140:143], v[28:31]
    s_waitcnt vmcnt(11)
    v_mul_f32 v225, v225, v109
    v_mul_f32 v226, v226, v110
    v_mfma_f32_16x16x32_bf16 v[32:35], a[236:239], a[64:67], v[32:35]
    global_load_dwordx4 a[164:167], v247, s[20:21] offset:1024
    v_mul_f32 v227, v227, v111
    v_mfma_f32_16x16x32_bf16 v[32:35], a[240:243], a[80:83], v[32:35]
    v_cvt_pk_bf16_f32 v106, v224, v225
    v_cvt_pk_bf16_f32 v107, v226, v227
    v_mfma_f32_16x16x32_bf16 v[32:35], a[188:191], a[96:99], v[32:35]
    global_load_dwordx4 a[168:171], v247, s[20:21] offset:2048
    v_add_f32 v228, v20, v212
    v_mfma_f32_16x16x32_bf16 v[32:35], a[192:195], a[112:115], v[32:35]
    s_waitcnt vmcnt(12)
    ds_write_b128 v248, v[104:107] offset:0
    v_mfma_f32_16x16x32_bf16 v[32:35], a[196:199], a[128:131], v[32:35]
    global_load_dwordx4 a[172:175], v247, s[20:21] offset:3072
    v_add_f32 v229, v21, v213
    v_mfma_f32_16x16x32_bf16 v[36:39], a[236:239], a[68:71], v[36:39]
    v_add_f32 v230, v22, v214
    v_add_f32 v231, v23, v215
    v_mfma_f32_16x16x32_bf16 v[36:39], a[240:243], a[84:87], v[36:39]
    v_mul_f32 v228, v228, v116
    v_mul_f32 v229, v229, v117
    v_mfma_f32_16x16x32_bf16 v[36:39], a[188:191], a[100:103], v[36:39]
    v_mul_f32 v230, v230, v118
    v_mul_f32 v231, v231, v119
    v_mfma_f32_16x16x32_bf16 v[36:39], a[192:195], a[116:119], v[36:39]
    v_cvt_pk_bf16_f32 v114, v228, v229
    v_cvt_pk_bf16_f32 v115, v230, v231
    v_mfma_f32_16x16x32_bf16 v[36:39], a[196:199], a[132:135], v[36:39]
    ds_write_b128 v248, v[112:115] offset:13312
    v_mfma_f32_16x16x32_bf16 v[40:43], a[236:239], a[72:75], v[40:43]
    v_add_f32 v224, v24, v212
    v_add_f32 v225, v25, v213
    v_mfma_f32_16x16x32_bf16 v[40:43], a[240:243], a[88:91], v[40:43]
    v_add_f32 v226, v26, v214
    v_add_f32 v227, v27, v215
    v_mfma_f32_16x16x32_bf16 v[40:43], a[188:191], a[104:107], v[40:43]
    v_mul_f32 v224, v224, v124
    v_mul_f32 v225, v225, v125
    v_mfma_f32_16x16x32_bf16 v[40:43], a[192:195], a[120:123], v[40:43]
    s_add_u32 s20, s22, 16384
    v_mul_f32 v226, v226, v126
    v_mul_f32 v227, v227, v127
    v_mfma_f32_16x16x32_bf16 v[40:43], a[196:199], a[136:139], v[40:43]
    s_addc_u32 s21, s23, 0
    v_cvt_pk_bf16_f32 v122, v224, v225
    v_cvt_pk_bf16_f32 v123, v226, v227
    v_mfma_f32_16x16x32_bf16 v[44:47], a[236:239], a[76:79], v[44:47]
    ds_write_b128 v249, v[120:123] offset:0
    v_mfma_f32_16x16x32_bf16 v[44:47], a[240:243], a[92:95], v[44:47]
    global_load_dwordx4 a[236:239], v247, s[20:21] offset:-4096
    ds_read_b128 v[220:223], v245 offset:2576
    v_mfma_f32_16x16x32_bf16 v[44:47], a[188:191], a[108:111], v[44:47]
    s_add_u32 s18, s22, 69632
    v_add_f32 v228, v28, v212
    v_add_f32 v229, v29, v213
    v_mfma_f32_16x16x32_bf16 v[44:47], a[192:195], a[124:127], v[44:47]
    s_addc_u32 s19, s23, 0
    v_add_f32 v230, v30, v214
    v_add_f32 v231, v31, v215
    v_mfma_f32_16x16x32_bf16 v[44:47], a[196:199], a[140:143], v[44:47]
    global_load_dwordx4 a[240:243], v246, s[18:19] offset:-4096 sc1
    v_mul_f32 v228, v228, v132
    v_mfma_f32_16x16x32_bf16 v[48:51], a[204:207], a[0:3], v[48:51]
    v_mul_f32 v229, v229, v133
    v_mul_f32 v230, v230, v134
    v_mfma_f32_16x16x32_bf16 v[48:51], a[208:211], a[16:19], v[48:51]
    global_load_dwordx4 a[188:191], v246, s[18:19] offset:-2048 sc1
    v_mul_f32 v231, v231, v135
    v_mfma_f32_16x16x32_bf16 v[48:51], a[220:223], a[32:35], v[48:51]
    v_cvt_pk_bf16_f32 v130, v228, v229
    v_cvt_pk_bf16_f32 v131, v230, v231
    v_mfma_f32_16x16x32_bf16 v[48:51], a[224:227], a[48:51], v[48:51]
    s_waitcnt vmcnt(15) lgkmcnt(4)
    global_load_dwordx4 a[192:195], v246, s[18:19] offset:0 sc1
    v_add_f32 v224, v32, v216
    v_mfma_f32_16x16x32_bf16 v[48:51], a[200:203], a[64:67], v[48:51]
    s_waitcnt vmcnt(15)
    ds_write_b128 v249, v[128:131] offset:13312
    v_mfma_f32_16x16x32_bf16 v[48:51], a[212:215], a[80:83], v[48:51]
    s_waitcnt vmcnt(14)
    global_load_dwordx4 a[196:199], v246, s[18:19] offset:2048 sc1
    v_add_f32 v225, v33, v217
    v_mfma_f32_16x16x32_bf16 v[48:51], a[216:219], a[96:99], v[48:51]
    s_waitcnt vmcnt(14)
    v_add_f32 v226, v34, v218
    v_add_f32 v227, v35, v219
    v_mfma_f32_16x16x32_bf16 v[48:51], a[228:231], a[112:115], v[48:51]
    s_waitcnt vmcnt(13)
    v_mul_f32 v224, v224, v136
    v_mul_f32 v225, v225, v137
    v_mfma_f32_16x16x32_bf16 v[48:51], a[232:235], a[128:131], v[48:51]
    v_mul_f32 v226, v226, v138
    v_mul_f32 v227, v227, v139
    v_mfma_f32_16x16x32_bf16 v[52:55], a[204:207], a[4:7], v[52:55]
    v_cvt_pk_bf16_f32 v136, v224, v225
    v_cvt_pk_bf16_f32 v137, v226, v227
    v_mfma_f32_16x16x32_bf16 v[52:55], a[208:211], a[20:23], v[52:55]
    s_waitcnt lgkmcnt(0)
    s_barrier
    v_mfma_f32_16x16x32_bf16 v[52:55], a[220:223], a[36:39], v[52:55]
    ds_read_b128 a[244:247], v254 offset:0
    v_add_f32 v228, v36, v216
    v_mfma_f32_16x16x32_bf16 v[52:55], a[224:227], a[52:55], v[52:55]
    ds_read_b128 a[248:251], v254 offset:1024
    v_add_f32 v229, v37, v217
    v_mfma_f32_16x16x32_bf16 v[52:55], a[200:203], a[68:71], v[52:55]
    ds_read_b128 a[252:255], v254 offset:7168
    v_add_f32 v230, v38, v218
    v_mfma_f32_16x16x32_bf16 v[52:55], a[212:215], a[84:87], v[52:55]
    v_add_f32 v231, v39, v219
    v_mul_f32 v228, v228, v144
    v_mfma_f32_16x16x32_bf16 v[52:55], a[216:219], a[100:103], v[52:55]
    v_mul_f32 v229, v229, v145
    v_mul_f32 v230, v230, v146
    v_mfma_f32_16x16x32_bf16 v[52:55], a[228:231], a[116:119], v[52:55]
    v_mul_f32 v231, v231, v147
    v_cvt_pk_bf16_f32 v144, v228, v229
    v_mfma_f32_16x16x32_bf16 v[52:55], a[232:235], a[132:135], v[52:55]
    s_waitcnt lgkmcnt(2)
    global_store_dwordx4 v255, a[244:247], s[10:11] offset:0 nt
    v_mfma_f32_16x16x32_bf16 v[56:59], a[204:207], a[8:11], v[56:59]
    v_cvt_pk_bf16_f32 v145, v230, v231
    v_add_f32 v224, v40, v216
    v_mfma_f32_16x16x32_bf16 v[56:59], a[208:211], a[24:27], v[56:59]
    v_add_f32 v225, v41, v217
    v_add_f32 v226, v42, v218
    v_mfma_f32_16x16x32_bf16 v[56:59], a[220:223], a[40:43], v[56:59]
    v_add_f32 v227, v43, v219
    v_mul_f32 v224, v224, v152
    v_mfma_f32_16x16x32_bf16 v[56:59], a[224:227], a[56:59], v[56:59]
    s_waitcnt lgkmcnt(1)
    global_store_dwordx4 v255, a[248:251], s[10:11] offset:128 nt
    v_mfma_f32_16x16x32_bf16 v[56:59], a[200:203], a[72:75], v[56:59]
    v_mul_f32 v225, v225, v153
    v_mul_f32 v226, v226, v154
    v_mfma_f32_16x16x32_bf16 v[56:59], a[212:215], a[88:91], v[56:59]
    v_mul_f32 v227, v227, v155
    v_cvt_pk_bf16_f32 v152, v224, v225
    v_mfma_f32_16x16x32_bf16 v[56:59], a[216:219], a[104:107], v[56:59]
    v_cvt_pk_bf16_f32 v153, v226, v227
    v_add_f32 v228, v44, v216
    v_mfma_f32_16x16x32_bf16 v[56:59], a[228:231], a[120:123], v[56:59]
    s_waitcnt lgkmcnt(0)
    global_store_dwordx4 v255, a[252:255], s[10:11] offset:896 nt
    v_mfma_f32_16x16x32_bf16 v[56:59], a[232:235], a[136:139], v[56:59]
    s_add_u32 s18, s22, 77824
    v_add_f32 v229, v45, v217
    v_add_f32 v230, v46, v218
    v_mfma_f32_16x16x32_bf16 v[60:63], a[204:207], a[12:15], v[60:63]
    s_addc_u32 s19, s23, 0
    v_add_f32 v231, v47, v219
    v_mul_f32 v228, v228, v160
    v_mfma_f32_16x16x32_bf16 v[60:63], a[208:211], a[28:31], v[60:63]
    global_load_dwordx4 a[204:207], v246, s[18:19] offset:-4096 sc1
    v_mul_f32 v229, v229, v161
    v_mfma_f32_16x16x32_bf16 v[60:63], a[220:223], a[44:47], v[60:63]
    v_mul_f32 v230, v230, v162
    v_mul_f32 v231, v231, v163
    v_mfma_f32_16x16x32_bf16 v[60:63], a[224:227], a[60:63], v[60:63]
    global_load_dwordx4 a[208:211], v246, s[18:19] offset:-2048 sc1
    v_cvt_pk_bf16_f32 v160, v228, v229
    v_mfma_f32_16x16x32_bf16 v[60:63], a[200:203], a[76:79], v[60:63]
    v_cvt_pk_bf16_f32 v161, v230, v231
    v_add_f32 v224, v48, v220
    v_mfma_f32_16x16x32_bf16 v[60:63], a[212:215], a[92:95], v[60:63]
    global_load_dwordx4 a[220:223], v246, s[18:19] offset:0 sc1
    ds_read_b128 v[208:211], v251 offset:2048
    v_mfma_f32_16x16x32_bf16 v[60:63], a[216:219], a[108:111], v[60:63]
    s_add_u32 s18, s22, 68608
    v_add_f32 v225, v49, v221
    v_add_f32 v226, v50, v222
    v_mfma_f32_16x16x32_bf16 v[60:63], a[228:231], a[124:127], v[60:63]
    s_addc_u32 s19, s23, 0
    v_add_f32 v227, v51, v223
    v_mul_f32 v224, v224, v140
    v_mfma_f32_16x16x32_bf16 v[60:63], a[232:235], a[140:143], v[60:63]
    s_waitcnt vmcnt(15)
    global_load_dwordx4 a[224:227], v246, s[18:19] offset:-4096 sc1
    v_mul_f32 v225, v225, v141
    v_mfma_f32_16x16x32_bf16 v[96:99], a[152:155], a[0:3], v[96:99]
    v_mul_f32 v226, v226, v142
    v_mul_f32 v227, v227, v143
    v_mfma_f32_16x16x32_bf16 v[96:99], a[156:159], a[16:19], v[96:99]
    global_load_dwordx4 a[200:203], v246, s[18:19] offset:-2048 sc1
    v_cvt_pk_bf16_f32 v138, v224, v225
    v_mfma_f32_16x16x32_bf16 v[96:99], a[160:163], a[32:35], v[96:99]
    v_cvt_pk_bf16_f32 v139, v226, v227
    v_add_f32 v228, v52, v220
    v_mfma_f32_16x16x32_bf16 v[96:99], a[144:147], a[48:51], v[96:99]
    s_waitcnt vmcnt(16)
    global_load_dwordx4 a[212:215], v246, s[18:19] offset:0 sc1
    v_add_f32 v229, v53, v221
    v_mfma_f32_16x16x32_bf16 v[96:99], a[148:151], a[64:67], v[96:99]
    s_waitcnt vmcnt(16)
    ds_write_b128 v248, v[136:139] offset:2048
    v_mfma_f32_16x16x32_bf16 v[96:99], a[164:167], a[80:83], v[96:99]
    s_waitcnt vmcnt(15)
    global_load_dwordx4 a[216:219], v246, s[18:19] offset:2048 sc1
    v_add_f32 v230, v54, v222
    v_mfma_f32_16x16x32_bf16 v[96:99], a[168:171], a[96:99], v[96:99]
    s_waitcnt vmcnt(15)
    v_add_f32 v231, v55, v223
    v_mul_f32 v228, v228, v148
    v_mfma_f32_16x16x32_bf16 v[96:99], a[172:175], a[112:115], v[96:99]
    s_waitcnt vmcnt(14)
    v_mul_f32 v229, v229, v149
    v_mul_f32 v230, v230, v150
    v_mfma_f32_16x16x32_bf16 v[96:99], a[236:239], a[128:131], v[96:99]
    s_add_u32 s18, s22, 76800
    v_mul_f32 v231, v231, v151
    v_cvt_pk_bf16_f32 v146, v228, v229
    v_mfma_f32_16x16x32_bf16 v[100:103], a[152:155], a[4:7], v[100:103]
    s_addc_u32 s19, s23, 0
    v_cvt_pk_bf16_f32 v147, v230, v231
    v_add_f32 v224, v56, v220
    v_mfma_f32_16x16x32_bf16 v[100:103], a[156:159], a[20:23], v[100:103]
    global_load_dwordx4 a[228:231], v246, s[18:19] offset:-4096 sc1
    v_add_f32 v225, v57, v221
    v_mfma_f32_16x16x32_bf16 v[100:103], a[160:163], a[36:39], v[100:103]
    ds_write_b128 v248, v[144:147] offset:15360
    v_mfma_f32_16x16x32_bf16 v[100:103], a[144:147], a[52:55], v[100:103]
    global_load_dwordx4 a[232:235], v246, s[18:19] offset:-2048 sc1
    v_add_f32 v226, v58, v222
    v_mfma_f32_16x16x32_bf16 v[100:103], a[148:151], a[68:71], v[100:103]
    v_add_f32 v227, v59, v223
    v_mul_f32 v224, v224, v156
    v_mfma_f32_16x16x32_bf16 v[100:103], a[164:167], a[84:87], v[100:103]
    global_load_dwordx4 a[152:155], v246, s[18:19] offset:0 sc1
    v_mul_f32 v225, v225, v157
    v_mfma_f32_16x16x32_bf16 v[100:103], a[168:171], a[100:103], v[100:103]
    v_mul_f32 v226, v226, v158
    v_mul_f32 v227, v227, v159
    v_mfma_f32_16x16x32_bf16 v[100:103], a[172:175], a[116:119], v[100:103]
    global_load_dwordx4 a[156:159], v246, s[18:19] offset:2048 sc1
    v_cvt_pk_bf16_f32 v154, v224, v225
    v_mfma_f32_16x16x32_bf16 v[100:103], a[236:239], a[132:135], v[100:103]
    s_waitcnt vmcnt(16)
    v_cvt_pk_bf16_f32 v155, v226, v227
    v_add_f32 v228, v60, v220
    v_mfma_f32_16x16x32_bf16 v[64:67], a[176:179], a[0:3], v[64:67]
    ds_write_b128 v249, v[152:155] offset:2048
    v_mfma_f32_16x16x32_bf16 v[64:67], a[180:183], a[16:19], v[64:67]
    v_add_f32 v229, v61, v221
    v_add_f32 v230, v62, v222
    v_mfma_f32_16x16x32_bf16 v[64:67], a[240:243], a[32:35], v[64:67]
    v_add_f32 v231, v63, v223
    v_mul_f32 v228, v228, v164
    v_mfma_f32_16x16x32_bf16 v[64:67], a[188:191], a[48:51], v[64:67]
    s_waitcnt vmcnt(15)
    ds_read_b128 v[216:219], v245 offset:3072
    v_mul_f32 v229, v229, v165
    v_mfma_f32_16x16x32_bf16 v[64:67], a[192:195], a[64:67], v[64:67]
    s_waitcnt vmcnt(14)
    v_mul_f32 v230, v230, v166
    v_mul_f32 v231, v231, v167
    v_mfma_f32_16x16x32_bf16 v[64:67], a[196:199], a[80:83], v[64:67]
    s_waitcnt vmcnt(10)
    v_cvt_pk_bf16_f32 v162, v228, v229
    v_cvt_pk_bf16_f32 v163, v230, v231
    v_mfma_f32_16x16x32_bf16 v[64:67], a[204:207], a[96:99], v[64:67]
    s_waitcnt vmcnt(9)
    ds_write_b128 v249, v[160:163] offset:15360
    v_mfma_f32_16x16x32_bf16 v[64:67], a[208:211], a[112:115], v[64:67]
    s_waitcnt vmcnt(8) lgkmcnt(5)
    v_add_f32 v224, v96, v208
    v_add_f32 v225, v97, v209
    v_mfma_f32_16x16x32_bf16 v[64:67], a[220:223], a[128:131], v[64:67]
    v_add_f32 v226, v98, v210
    v_add_f32 v227, v99, v211
    v_mfma_f32_16x16x32_bf16 v[68:71], a[176:179], a[4:7], v[68:71]
    v_mul_f32 v224, v224, v200
    v_mul_f32 v225, v225, v201
    v_mfma_f32_16x16x32_bf16 v[68:71], a[180:183], a[20:23], v[68:71]
    v_mul_f32 v226, v226, v202
    v_mul_f32 v227, v227, v203
    v_mfma_f32_16x16x32_bf16 v[68:71], a[240:243], a[36:39], v[68:71]
    v_cvt_pk_bf16_f32 v200, v224, v225
    v_cvt_pk_bf16_f32 v201, v226, v227
    v_mfma_f32_16x16x32_bf16 v[68:71], a[188:191], a[52:55], v[68:71]
    ds_write_b64 v250, v[200:201] offset:6144
    v_mfma_f32_16x16x32_bf16 v[68:71], a[192:195], a[68:71], v[68:71]
    v_add_f32 v228, v100, v208
    v_add_f32 v229, v101, v209
    v_mfma_f32_16x16x32_bf16 v[68:71], a[196:199], a[84:87], v[68:71]
    v_add_f32 v230, v102, v210
    v_add_f32 v231, v103, v211
    v_mfma_f32_16x16x32_bf16 v[68:71], a[204:207], a[100:103], v[68:71]
    v_mul_f32 v228, v228, v204
    v_mul_f32 v229, v229, v205
    v_mfma_f32_16x16x32_bf16 v[68:71], a[208:211], a[116:119], v[68:71]
    v_mul_f32 v230, v230, v206
    v_mul_f32 v231, v231, v207
    v_mfma_f32_16x16x32_bf16 v[68:71], a[220:223], a[132:135], v[68:71]
    v_cvt_pk_bf16_f32 v204, v228, v229
    v_cvt_pk_bf16_f32 v205, v230, v231
    v_mfma_f32_16x16x32_bf16 v[72:75], a[176:179], a[8:11], v[72:75]
    ds_write_b64 v250, v[204:205] offset:19456
    v_mfma_f32_16x16x32_bf16 v[72:75], a[180:183], a[24:27], v[72:75]
    s_waitcnt lgkmcnt(3)
    v_add_f32 v224, v64, v216
    v_add_f32 v225, v65, v217
    v_mfma_f32_16x16x32_bf16 v[72:75], a[240:243], a[40:43], v[72:75]
    v_add_f32 v226, v66, v218
    v_add_f32 v227, v67, v219
    v_mfma_f32_16x16x32_bf16 v[72:75], a[188:191], a[56:59], v[72:75]
    v_mul_f32 v224, v224, v168
    v_mul_f32 v225, v225, v169
    v_mfma_f32_16x16x32_bf16 v[72:75], a[192:195], a[72:75], v[72:75]
    v_mul_f32 v226, v226, v170
    v_mul_f32 v227, v227, v171
    v_mfma_f32_16x16x32_bf16 v[72:75], a[196:199], a[88:91], v[72:75]
    v_cvt_pk_bf16_f32 v168, v224, v225
    v_cvt_pk_bf16_f32 v169, v226, v227
    v_mfma_f32_16x16x32_bf16 v[72:75], a[204:207], a[104:107], v[72:75]
    s_waitcnt lgkmcnt(0)
    s_barrier
    v_mfma_f32_16x16x32_bf16 v[72:75], a[208:211], a[120:123], v[72:75]
    ds_read_b128 a[160:163], v254 offset:2048
    v_add_f32 v228, v68, v216
    v_mfma_f32_16x16x32_bf16 v[72:75], a[220:223], a[136:139], v[72:75]
    ds_read_b128 a[144:147], v254 offset:3072
    v_add_f32 v229, v69, v217
    v_mfma_f32_16x16x32_bf16 v[76:79], a[176:179], a[12:15], v[76:79]
    ds_read_b128 a[148:151], v254 offset:8192
    v_add_f32 v230, v70, v218
    v_mfma_f32_16x16x32_bf16 v[76:79], a[180:183], a[28:31], v[76:79]
    ds_read_b128 a[164:167], v254 offset:9216
    v_add_f32 v231, v71, v219
    v_mfma_f32_16x16x32_bf16 v[76:79], a[240:243], a[44:47], v[76:79]
    ds_read_b128 a[168:171], v254 offset:6144
    v_mul_f32 v228, v228, v176
    v_mfma_f32_16x16x32_bf16 v[76:79], a[188:191], a[60:63], v[76:79]
    v_mul_f32 v229, v229, v177
    v_mul_f32 v230, v230, v178
    v_mfma_f32_16x16x32_bf16 v[76:79], a[192:195], a[76:79], v[76:79]
    s_waitcnt lgkmcnt(4)
    global_store_dwordx4 v255, a[160:163], s[10:11] offset:256 nt
    v_mfma_f32_16x16x32_bf16 v[76:79], a[196:199], a[92:95], v[76:79]
    ds_read_b128 v[220:223], v245 offset:3088
    v_mul_f32 v231, v231, v179
    v_mfma_f32_16x16x32_bf16 v[76:79], a[204:207], a[108:111], v[76:79]
    v_cvt_pk_bf16_f32 v176, v228, v229
    v_cvt_pk_bf16_f32 v177, v230, v231
    v_mfma_f32_16x16x32_bf16 v[76:79], a[208:211], a[124:127], v[76:79]
    v_add_f32 v224, v72, v216
    v_add_f32 v225, v73, v217
    v_mfma_f32_16x16x32_bf16 v[76:79], a[220:223], a[140:143], v[76:79]
    s_waitcnt vmcnt(6) lgkmcnt(4)
    global_store_dwordx4 v255, a[144:147], s[10:11] offset:384 nt
    v_mfma_f32_16x16x32_bf16 v[80:83], a[184:187], a[0:3], v[80:83]
    v_add_f32 v226, v74, v218
    v_add_f32 v227, v75, v219
    v_mfma_f32_16x16x32_bf16 v[80:83], a[224:227], a[16:19], v[80:83]
    v_mul_f32 v224, v224, v184
    v_mul_f32 v225, v225, v185
    v_mfma_f32_16x16x32_bf16 v[80:83], a[200:203], a[32:35], v[80:83]
    v_mul_f32 v226, v226, v186
    v_mul_f32 v227, v227, v187
    v_mfma_f32_16x16x32_bf16 v[80:83], a[212:215], a[48:51], v[80:83]
    s_waitcnt vmcnt(6) lgkmcnt(3)
    global_store_dwordx4 v255, a[148:151], s[10:11] offset:1024 nt
    v_mfma_f32_16x16x32_bf16 v[80:83], a[216:219], a[64:67], v[80:83]
    s_waitcnt vmcnt(6)
    v_cvt_pk_bf16_f32 v184, v224, v225
    v_cvt_pk_bf16_f32 v185, v226, v227
    v_mfma_f32_16x16x32_bf16 v[80:83], a[228:231], a[80:83], v[80:83]
    s_waitcnt vmcnt(5)
    v_mfma_f32_16x16x32_bf16 v[80:83], a[232:235], a[96:99], v[80:83]
    s_waitcnt vmcnt(4)
    v_mfma_f32_16x16x32_bf16 v[80:83], a[152:155], a[112:115], v[80:83]
    s_waitcnt vmcnt(3) lgkmcnt(2)
    global_store_dwordx4 v255, a[164:167], s[10:11] offset:1152 nt
    v_mfma_f32_16x16x32_bf16 v[80:83], a[156:159], a[128:131], v[80:83]
    v_add_f32 v228, v76, v216
    v_add_f32 v229, v77, v217
    v_mfma_f32_16x16x32_bf16 v[84:87], a[184:187], a[4:7], v[84:87]
    v_add_f32 v230, v78, v218
    v_add_f32 v231, v79, v219
    v_mfma_f32_16x16x32_bf16 v[84:87], a[224:227], a[20:23], v[84:87]
    v_mul_f32 v228, v228, v192
    v_mul_f32 v229, v229, v193
    v_mfma_f32_16x16x32_bf16 v[84:87], a[200:203], a[36:39], v[84:87]
    s_waitcnt lgkmcnt(1)
    global_store_dwordx4 v255, a[168:171], s[10:11] offset:768 nt
    v_mfma_f32_16x16x32_bf16 v[84:87], a[212:215], a[52:55], v[84:87]
    v_mul_f32 v230, v230, v194
    v_mul_f32 v231, v231, v195
    v_mfma_f32_16x16x32_bf16 v[84:87], a[216:219], a[68:71], v[84:87]
    v_cvt_pk_bf16_f32 v192, v228, v229
    v_cvt_pk_bf16_f32 v193, v230, v231
    v_mfma_f32_16x16x32_bf16 v[84:87], a[228:231], a[84:87], v[84:87]
    v_mfma_f32_16x16x32_bf16 v[84:87], a[232:235], a[100:103], v[84:87]
    v_mfma_f32_16x16x32_bf16 v[84:87], a[152:155], a[116:119], v[84:87]
    s_waitcnt lgkmcnt(0)
    v_add_f32 v224, v80, v220
    v_add_f32 v225, v81, v221
    v_mfma_f32_16x16x32_bf16 v[84:87], a[156:159], a[132:135], v[84:87]
    v_add_f32 v226, v82, v222
    v_add_f32 v227, v83, v223
    v_mfma_f32_16x16x32_bf16 v[88:91], a[184:187], a[8:11], v[88:91]
    v_mul_f32 v224, v224, v172
    v_mul_f32 v225, v225, v173
    v_mfma_f32_16x16x32_bf16 v[88:91], a[224:227], a[24:27], v[88:91]
    v_mul_f32 v226, v226, v174
    v_mul_f32 v227, v227, v175
    v_mfma_f32_16x16x32_bf16 v[88:91], a[200:203], a[40:43], v[88:91]
    v_cvt_pk_bf16_f32 v170, v224, v225
    v_cvt_pk_bf16_f32 v171, v226, v227
    v_mfma_f32_16x16x32_bf16 v[88:91], a[212:215], a[56:59], v[88:91]
    ds_write_b128 v248, v[168:171] offset:4096
    v_mfma_f32_16x16x32_bf16 v[88:91], a[216:219], a[72:75], v[88:91]
    v_mfma_f32_16x16x32_bf16 v[88:91], a[228:231], a[88:91], v[88:91]
    v_mfma_f32_16x16x32_bf16 v[88:91], a[232:235], a[104:107], v[88:91]
    v_mfma_f32_16x16x32_bf16 v[88:91], a[152:155], a[120:123], v[88:91]
    v_add_f32 v228, v84, v220
    v_add_f32 v229, v85, v221
    v_mfma_f32_16x16x32_bf16 v[88:91], a[156:159], a[136:139], v[88:91]
    v_add_f32 v230, v86, v222
    v_add_f32 v231, v87, v223
    v_mfma_f32_16x16x32_bf16 v[92:95], a[184:187], a[12:15], v[92:95]
    v_mul_f32 v228, v228, v180
    v_mul_f32 v229, v229, v181
    v_mfma_f32_16x16x32_bf16 v[92:95], a[224:227], a[28:31], v[92:95]
    v_mul_f32 v230, v230, v182
    v_mul_f32 v231, v231, v183
    v_mfma_f32_16x16x32_bf16 v[92:95], a[200:203], a[44:47], v[92:95]
    v_cvt_pk_bf16_f32 v178, v228, v229
    v_cvt_pk_bf16_f32 v179, v230, v231
    v_mfma_f32_16x16x32_bf16 v[92:95], a[212:215], a[60:63], v[92:95]
    ds_write_b128 v248, v[176:179] offset:17408
    v_mfma_f32_16x16x32_bf16 v[92:95], a[216:219], a[76:79], v[92:95]
    v_mfma_f32_16x16x32_bf16 v[92:95], a[228:231], a[92:95], v[92:95]
    v_mfma_f32_16x16x32_bf16 v[92:95], a[232:235], a[108:111], v[92:95]
    v_mfma_f32_16x16x32_bf16 v[92:95], a[152:155], a[124:127], v[92:95]
    v_add_f32 v224, v88, v220
    v_add_f32 v225, v89, v221
    v_mfma_f32_16x16x32_bf16 v[92:95], a[156:159], a[140:143], v[92:95]
    v_pk_add_f32 v[226:227], v[90:91], v[222:223]
    v_pk_mul_f32 v[224:225], v[224:225], v[188:189]
    v_pk_mul_f32 v[226:227], v[226:227], v[190:191]
    v_cvt_pk_bf16_f32 v186, v224, v225
    v_cvt_pk_bf16_f32 v187, v226, v227
    ds_write_b128 v249, v[184:187] offset:4096
    s_nop 1
    v_pk_add_f32 v[228:229], v[92:93], v[220:221]
    v_pk_add_f32 v[230:231], v[94:95], v[222:223]
    v_pk_mul_f32 v[228:229], v[228:229], v[196:197]
    v_pk_mul_f32 v[230:231], v[230:231], v[198:199]
    v_cvt_pk_bf16_f32 v194, v228, v229
    v_cvt_pk_bf16_f32 v195, v230, v231
    ds_write_b128 v249, v[192:195] offset:17408
    s_waitcnt lgkmcnt(0)
    s_barrier
    ds_read_b128 a[172:175], v254 offset:4096
    ds_read_b128 a[236:239], v254 offset:5120
    ds_read_b128 a[176:179], v254 offset:10240
    ds_read_b128 a[180:183], v254 offset:11264
    ds_read_b128 a[240:243], v254 offset:12288
    s_waitcnt lgkmcnt(4)
    global_store_dwordx4 v255, a[172:175], s[10:11] offset:512 nt
    s_waitcnt lgkmcnt(3)
    global_store_dwordx4 v255, a[236:239], s[10:11] offset:640 nt
    s_waitcnt lgkmcnt(2)
    global_store_dwordx4 v255, a[176:179], s[10:11] offset:1280 nt
    s_waitcnt lgkmcnt(1)
    global_store_dwordx4 v255, a[180:183], s[10:11] offset:1408 nt
    s_waitcnt lgkmcnt(0)
    global_store_dwordx4 v255, a[240:243], s[10:11] offset:1536 nt
L_end:
    s_endpgm
L_var1:
    s_add_u32 m0, s3, 0
    s_nop 0
    global_load_lds_dwordx4 v6, s[6:7]
    s_add_u32 m0, s3, 1024
    s_nop 0
    global_load_lds_dwordx4 v8, s[6:7]
    s_add_u32 m0, s3, 2048
    s_nop 0
    global_load_lds_dwordx4 v32, s[6:7]
    s_add_u32 m0, s3, 3072
    s_nop 0
    global_load_lds_dwordx4 v33, s[6:7]
    s_add_u32 s8, s8, 2496
    s_addc_u32 s9, s9, 0
    global_load_dword v208, v26, s[8:9] offset:-2496
    global_load_dword v209, v26, s[8:9] offset:-1664
    global_load_dword v210, v26, s[8:9] offset:-832
    global_load_dword v211, v26, s[8:9] offset:0
    global_load_dword v212, v26, s[8:9] offset:832
    global_load_dword v213, v26, s[8:9] offset:1664
    s_add_u32 m0, s35, 56320
    s_add_u32 s28, s6, 3072
    s_addc_u32 s29, s7, 0
    global_load_lds_dwordx4 v239, s[28:29] offset:-3072
    global_load_lds_dwordx4 v239, s[28:29] offset:-2048
    global_load_lds_dwordx4 v239, s[28:29] offset:-1024
    global_load_lds_dwordx4 v239, s[28:29] offset:0
    global_load_lds_dwordx4 v239, s[28:29] offset:1024
    global_load_lds_dwordx4 v239, s[28:29] offset:2048
    s_mov_b32 exec_hi, 0
    global_load_lds_dwordx4 v239, s[28:29] offset:3072
    s_mov_b32 exec_hi, -1
    s_add_u32 m0, s35, 69632
    s_add_u32 s28, s6, 29696
    s_addc_u32 s29, s7, 0
    global_load_lds_dwordx4 v239, s[28:29] offset:-3072
    global_load_lds_dwordx4 v239, s[28:29] offset:-2048
    global_load_lds_dwordx4 v239, s[28:29] offset:-1024
    global_load_lds_dwordx4 v239, s[28:29] offset:0
    global_load_lds_dwordx4 v239, s[28:29] offset:1024
    global_load_lds_dwordx4 v239, s[28:29] offset:2048
    s_mov_b32 exec_hi, 0
    global_load_lds_dwordx4 v239, s[28:29] offset:3072
    s_mov_b32 exec_hi, -1
    s_add_u32 m0, s35, 82944
    s_add_u32 s28, s6, 56320
    s_addc_u32 s29, s7, 0
    global_load_lds_dwordx4 v239, s[28:29] offset:-3072
    global_load_lds_dwordx4 v239, s[28:29] offset:-2048
    global_load_lds_dwordx4 v239, s[28:29] offset:-1024
    global_load_lds_dwordx4 v239, s[28:29] offset:0
    global_load_lds_dwordx4 v239, s[28:29] offset:1024
    global_load_lds_dwordx4 v239, s[28:29] offset:2048
    s_mov_b32 exec_hi, 0
    global_load_lds_dwordx4 v239, s[28:29] offset:3072
    s_mov_b32 exec_hi, -1
    s_mul_i32 s90, s88, 5042
    s_lshr_b32 s90, s90, 16
    s_mul_i32 s91, s90, 13
    s_sub_u32 s88, s88, s91
    s_mul_i32 s86, s90, 352256
    s_and_b32 s90, s89, 3
    s_mul_i32 s90, s90, 79872
    s_lshr_b32 s91, s89, 2
    s_mul_i32 s91, s91, 26624
    s_add_u32 s90, s90, s91
    s_lshl_b32 s91, s88, 11
    s_add_u32 s90, s90, s91
    s_lshl_b32 s91, s88, 10
    s_add_u32 s91, s91, 319488
    s_cmp_lt_u32 s89, 12
    s_cselect_b32 s90, s90, s91
    s_cselect_b32 s87, 1, 13
    s_lshl_b32 s87, s87, 10
    s_add_u32 s86, s86, s90
    v_add_u32 v9, s86, v4
    v_add_u32 v10, s87, v9
    s_mul_i32 s98, s96, 5042
    s_lshr_b32 s98, s98, 16
    s_mul_i32 s99, s98, 13
    s_sub_u32 s96, s96, s99
    s_mul_i32 s94, s98, 352256
    s_and_b32 s98, s97, 3
    s_mul_i32 s98, s98, 79872
    s_lshr_b32 s99, s97, 2
    s_mul_i32 s99, s99, 26624
    s_add_u32 s98, s98, s99
    s_lshl_b32 s99, s96, 11
    s_add_u32 s98, s98, s99
    s_lshl_b32 s99, s96, 10
    s_add_u32 s99, s99, 319488
    s_cmp_lt_u32 s97, 12
    s_cselect_b32 s98, s98, s99
    s_cselect_b32 s95, 1, 13
    s_lshl_b32 s95, s95, 10
    s_add_u32 s94, s94, s98
    v_add_u32 v34, s94, v4
    v_add_u32 v35, s95, v34
    v_and_b32 v2, 15, v0
    v_lshrrev_b32 v3, 4, v1
    v_lshrrev_b32 v13, 2, v2
    v_lshl_add_u32 v11, v3, 3, v13
    v_lshlrev_b32 v11, 6, v11
    v_lshl_add_u32 v11, v7, 4, v11
    v_add_u32 v11, s3, v11
    s_lshl_b32 s43, s16, 6
    s_lshl_b32 s44, s25, 3
    v_and_b32 v14, 1, v3
    v_mul_u32_u24 v253, 53256, v14
    v_lshrrev_b32 v14, 1, v3
    v_mul_u32_u24 v14, 6656, v14
    v_mul_u32_u24 v13, 832, v13
    v_add3_u32 v253, v253, v14, v13
    v_lshl_add_u32 v253, v7, 4, v253
    s_add_u32 s45, s44, 54016
    v_add_u32 v254, s45, v253
    s_add_u32 s45, s43, 53248
    v_add_u32 v253, s45, v253
    v_and_b32 v13, 1, v2
    v_lshl_add_u32 v14, v13, 2, v3
    v_bfe_u32 v15, v2, 1, 2
    v_xor_b32 v14, v14, v15
    v_lshlrev_b32 v14, 4, v14
    v_lshrrev_b32 v15, 1, v2
    v_lshl_add_u32 v14, v15, 7, v14
    v_mul_u32_u24 v15, 6144, v13
    v_add_u32 v14, v14, v15
    v_xor_b32 v15, 64, v14
    v_lshl_add_u32 v15, v13, 10, v15
    s_mul_i32 s45, s24, 26624
    s_sub_u32 s46, 26624, s45
    v_add_u32 v214, s45, v14
    v_add_u32 v215, s46, v14
    v_add_u32 v216, s45, v15
    v_add_u32 v218, s46, v15
    s_cmp_eq_u32 s24, 1
    s_cselect_b64 vcc, -1, 0
    s_lshl_b32 s47, s25, 10
    v_cndmask_b32 v236, v214, v216, vcc
    v_cndmask_b32 v237, v215, v218, vcc
    v_add_u32 v236, s47, v236
    v_add_u32 v237, s47, v237
    v_add_u32 v238, s44, v214
    v_add_u32 v248, 106496, v236
    v_add_u32 v249, 106496, v237
    v_add_u32 v250, 106496, v238
    s_mul_i32 s26, s16, 66560
    s_sub_u32 s26, 106496, s26
    s_lshl_b32 s45, s24, 11
    s_sub_u32 s46, 2048, s45
    s_lshl_b32 s47, s16, 12
    v_add_u32 v240, s45, v4
    v_add_u32 v241, s46, v4
    v_add_u32 v242, s47, v240
    v_add_u32 v243, s47, v241
    s_add_u32 s45, s44, 49152
    v_add_u32 v244, s45, v240
    v_lshlrev_b32 v245, 5, v3
    s_lshl_b32 s45, s25, 4
    s_add_u32 s45, s45, 68096
    v_add_u32 v251, s45, v245
    s_lshl_b32 s45, s16, 7
    s_add_u32 s45, s45, 66560
    v_add_u32 v245, s45, v245
    s_mul_i32 s45, s25, 13312
    s_add_u32 s45, s45, 319488
    v_add_u32 v247, s45, v4
    s_mul_i32 s45, s16, 79872
    v_add_u32 v246, s45, v4
    s_add_u32 s22, s14, 352256
    s_addc_u32 s23, s15, 0
    s_mul_i32 s45, s16, 79872
    s_add_u32 s72, s14, s45
    s_addc_u32 s73, s15, 0
    s_and_b32 s73, s73, 0xffff
    s_or_b32 s73, s73, 0x100000
    s_mov_b32 s74, 2113536
    s_mov_b32 s75, 0x00800000
    s_mul_i32 s45, s25, 13312
    s_add_u32 s45, s45, 319488
    s_add_u32 s76, s14, s45
    s_addc_u32 s77, s15, 0
    s_and_b32 s77, s77, 0xffff
    s_or_b32 s77, s77, 0x100000
    s_mov_b32 s78, 2113536
    s_mov_b32 s79, 0x00800000
    s_mov_b32 s80, 352256
    s_mov_b64 s[18:19], s[22:23]
    s_mov_b64 s[20:21], s[22:23]
    s_mov_b64 s[36:37], s[22:23]
    s_cmp_eq_u32 s16, 0
    s_cselect_b32 s32, 15, 0
    s_cselect_b32 s30, 1, 0
    s_mov_b32 s33, 0
    s_cmp_lt_u32 s83, 108
    s_cselect_b32 s30, s30, 0
    s_mov_b32 s31, 0
    s_and_b32 s45, s83, 3
    s_lshl_b32 s45, s45, 6
    v_mov_b32 v223, s45
    v_lshlrev_b32 v222, 6, v7
    v_mov_b32 v221, 27
    v_mov_b32 v220, 1
    v_mov_b32 v224, 0x412a0000
    v_mov_b32 v225, 0x412a0000
    v_mov_b32 v226, 0x412a0000
    v_mov_b32 v227, 0x412a0000
    v_lshlrev_b32 v217, 3, v0
    v_add_u32 v217, 66560, v217
    s_mov_b32 s17, 4
    s_bitcmp1_b32 s2, 3
    s_cselect_b32 s0, 0, 24
    s_waitcnt vmcnt(27)
    ds_read_b64_tr_b16 v[36:37], v11 offset:0
    ds_read_b64_tr_b16 v[38:39], v11 offset:256
    ds_read_b64_tr_b16 v[40:41], v11 offset:8
    ds_read_b64_tr_b16 v[42:43], v11 offset:264
    ds_read_b64_tr_b16 v[44:45], v11 offset:2048
    ds_read_b64_tr_b16 v[46:47], v11 offset:2304
    ds_read_b64_tr_b16 v[48:49], v11 offset:2056
    ds_read_b64_tr_b16 v[50:51], v11 offset:2312
    s_waitcnt lgkmcnt(6)
    global_store_dwordx4 v9, v[36:39], s[14:15] sc1
    s_waitcnt lgkmcnt(4)
    global_store_dwordx4 v10, v[40:43], s[14:15] sc1
    s_waitcnt lgkmcnt(2)
    global_store_dwordx4 v34, v[44:47], s[14:15] sc1
    s_waitcnt lgkmcnt(0)
    global_store_dwordx4 v35, v[48:51], s[14:15] sc1
    s_add_u32 m0, s35, 96256
    s_add_u32 s28, s6, 82944
    s_addc_u32 s29, s7, 0
    global_load_lds_dwordx4 v239, s[28:29] offset:-3072
    global_load_lds_dwordx4 v239, s[28:29] offset:-2048
    global_load_lds_dwordx4 v239, s[28:29] offset:-1024
    global_load_lds_dwordx4 v239, s[28:29] offset:0
    global_load_lds_dwordx4 v239, s[28:29] offset:1024
    global_load_lds_dwordx4 v239, s[28:29] offset:2048
    s_mov_b32 exec_hi, 0
    global_load_lds_dwordx4 v239, s[28:29] offset:3072
    s_mov_b32 exec_hi, -1
    s_waitcnt vmcnt(7)
    s_barrier
    s_mov_b64 exec, s[30:31]
    s_cbranch_execz L_skip_sig_b
    global_atomic_add v223, v220, s[12:13] sc1
L_skip_sig_b:
    s_mov_b64 exec, -1
    s_add_u32 m0, s34, 0
    s_nop 0
    global_load_lds_dwordx4 v255, s[4:5] offset:0 nt
    s_add_u32 m0, s34, 5376
    s_nop 0
    global_load_lds_dwordx4 v255, s[4:5] offset:768 nt
    s_add_u32 m0, s34, 6272
    s_nop 0
    global_load_lds_dwordx4 v255, s[4:5] offset:896 nt
    s_add_u32 m0, s34, 896
    s_nop 0
    global_load_lds_dwordx4 v255, s[4:5] offset:128 nt
    s_add_u32 m0, s34, 7168
    s_nop 0
    global_load_lds_dwordx4 v255, s[4:5] offset:1024 nt
    s_add_u32 m0, s34, 1792
    s_nop 0
    global_load_lds_dwordx4 v255, s[4:5] offset:256 nt
    s_add_u32 m0, s34, 8064
    s_nop 0
    global_load_lds_dwordx4 v255, s[4:5] offset:1152 nt
    s_add_u32 m0, s34, 2688
    s_nop 0
    global_load_lds_dwordx4 v255, s[4:5] offset:384 nt
    s_add_u32 m0, s34, 8960
    s_nop 0
    global_load_lds_dwordx4 v255, s[4:5] offset:1280 nt
    s_add_u32 m0, s34, 3584
    s_nop 0
    global_load_lds_dwordx4 v255, s[4:5] offset:512 nt
    s_add_u32 m0, s34, 9856
    s_nop 0
    global_load_lds_dwordx4 v255, s[4:5] offset:1408 nt
    s_add_u32 m0, s34, 4480
    s_nop 0
    global_load_lds_dwordx4 v255, s[4:5] offset:640 nt
    s_add_u32 m0, s34, 10752
    s_nop 0
    global_load_lds_dwordx4 v255, s[4:5] offset:1536 nt
    ds_read_b64_tr_b16 a[180:181], v253 offset:0
    ds_read_b64_tr_b16 a[182:183], v253 offset:3328
    ds_read_b64_tr_b16 a[148:149], v253 offset:8
    ds_read_b64_tr_b16 a[150:151], v253 offset:3336
    ds_read_b64_tr_b16 a[216:217], v253 offset:256
    ds_read_b64_tr_b16 a[218:219], v253 offset:3584
    ds_read_b64_tr_b16 a[160:161], v253 offset:264
    ds_read_b64_tr_b16 a[162:163], v253 offset:3592
    ds_read_b64_tr_b16 a[252:253], v253 offset:512
    ds_read_b64_tr_b16 a[254:255], v253 offset:3840
    ds_read_b64_tr_b16 a[192:193], v253 offset:520
    ds_read_b64_tr_b16 a[194:195], v253 offset:3848
    ds_read_b64_tr_b16 a[152:153], v254 offset:0
    ds_read_b64_tr_b16 a[154:155], v254 offset:3328
    ds_read_b64_tr_b16 a[228:229], v253 offset:13312
    ds_read_b64_tr_b16 a[230:231], v253 offset:16640
    ds_read_b64_tr_b16 a[164:165], v253 offset:13320
    ds_read_b64_tr_b16 a[166:167], v253 offset:16648
    ds_read_b64_tr_b16 a[144:145], v253 offset:13568
    ds_read_b64_tr_b16 a[146:147], v253 offset:16896
    ds_read_b64_tr_b16 a[204:205], v253 offset:13576
    ds_read_b64_tr_b16 a[206:207], v253 offset:16904
    ds_read_b64_tr_b16 a[156:157], v253 offset:13824
    ds_read_b64_tr_b16 a[158:159], v253 offset:17152
    ds_read_b64_tr_b16 a[240:241], v253 offset:13832
    ds_read_b64_tr_b16 a[242:243], v253 offset:17160
    ds_read_b64_tr_b16 a[168:169], v254 offset:13312
    ds_read_b64_tr_b16 a[170:171], v254 offset:16640
    ds_read_b64_tr_b16 a[172:173], v253 offset:26624
    ds_read_b64_tr_b16 a[174:175], v253 offset:29952
    ds_read_b64_tr_b16 a[220:221], v253 offset:26632
    ds_read_b64_tr_b16 a[222:223], v253 offset:29960
    ds_read_b64_tr_b16 a[188:189], v253 offset:26880
    ds_read_b64_tr_b16 a[190:191], v253 offset:30208
    ds_read_b64_tr_b16 a[236:237], v253 offset:26888
    ds_read_b64_tr_b16 a[238:239], v253 offset:30216
    ds_read_b64_tr_b16 a[208:209], v253 offset:27136
    ds_read_b64_tr_b16 a[210:211], v253 offset:30464
    ds_read_b64_tr_b16 a[176:177], v253 offset:27144
    ds_read_b64_tr_b16 a[178:179], v253 offset:30472
    ds_read_b64_tr_b16 a[224:225], v254 offset:26624
    ds_read_b64_tr_b16 a[226:227], v254 offset:29952
    s_waitcnt vmcnt(13)
    s_barrier
    ds_read_b64_tr_b16 a[196:197], v253 offset:39936
    ds_read_b64_tr_b16 a[198:199], v253 offset:43264
    ds_read_b64_tr_b16 a[244:245], v253 offset:39944
    ds_read_b64_tr_b16 a[246:247], v253 offset:43272
    ds_read_b64_tr_b16 a[212:213], v253 offset:40192
    ds_read_b64_tr_b16 a[214:215], v253 offset:43520
    ds_read_b64_tr_b16 a[184:185], v253 offset:40200
    ds_read_b64_tr_b16 a[186:187], v253 offset:43528
    ds_read_b64_tr_b16 a[232:233], v253 offset:40448
    ds_read_b64_tr_b16 a[234:235], v253 offset:43776
    ds_read_b64_tr_b16 a[200:201], v253 offset:40456
    ds_read_b64_tr_b16 a[202:203], v253 offset:43784
    ds_read_b64_tr_b16 a[248:249], v254 offset:39936
    ds_read_b64_tr_b16 a[250:251], v254 offset:43264
    s_waitcnt vmcnt(8) lgkmcnt(0)
    s_barrier
    ds_read_b128 a[0:3], v214 offset:0
    ds_read_b128 a[16:19], v216 offset:0
    ds_read_b128 a[4:7], v214 offset:13312
    ds_read_b128 a[20:23], v216 offset:13312
    ds_read_b128 a[8:11], v215 offset:0
    ds_read_b128 a[24:27], v218 offset:0
    ds_read_b128 a[12:15], v215 offset:13312
    ds_read_b128 a[28:31], v218 offset:13312
    s_waitcnt lgkmcnt(7)
    v_mfma_f32_16x16x32_bf16 v[0:3], a[180:183], a[0:3], v[224:227]
    s_waitcnt lgkmcnt(6)
    ds_read_b128 a[32:35], v214 offset:1024
    v_mfma_f32_16x16x32_bf16 v[0:3], a[228:231], a[16:19], v[0:3]
    s_waitcnt lgkmcnt(6)
    ds_read_b128 a[48:51], v216 offset:1024
    v_mfma_f32_16x16x32_bf16 v[4:7], a[180:183], a[4:7], v[224:227]
    s_waitcnt lgkmcnt(6)
    ds_read_b128 a[36:39], v214 offset:14336
    v_mfma_f32_16x16x32_bf16 v[4:7], a[228:231], a[20:23], v[4:7]
    s_waitcnt lgkmcnt(6)
    ds_read_b128 a[52:55], v216 offset:14336
    v_mfma_f32_16x16x32_bf16 v[8:11], a[180:183], a[8:11], v[224:227]
    s_waitcnt lgkmcnt(6)
    ds_read_b128 a[40:43], v215 offset:1024
    v_mfma_f32_16x16x32_bf16 v[8:11], a[228:231], a[24:27], v[8:11]
    s_waitcnt lgkmcnt(6)
    ds_read_b128 a[56:59], v218 offset:1024
    v_mfma_f32_16x16x32_bf16 v[12:15], a[180:183], a[12:15], v[224:227]
    s_waitcnt lgkmcnt(6)
    ds_read_b128 a[44:47], v215 offset:14336
    v_mfma_f32_16x16x32_bf16 v[12:15], a[228:231], a[28:31], v[12:15]
    ds_read_b128 a[60:63], v218 offset:14336
    v_mfma_f32_16x16x32_bf16 v[16:19], a[148:151], a[0:3], v[224:227]
    ds_read_b128 v[108:111], v236 offset:0
    v_mfma_f32_16x16x32_bf16 v[16:19], a[164:167], a[16:19], v[16:19]
    s_add_u32 m0, s35, 56320
    ds_read_b128 v[116:119], v236 offset:13312
    s_add_u32 s28, s6, 109568
    v_mfma_f32_16x16x32_bf16 v[20:23], a[148:151], a[4:7], v[224:227]
    s_addc_u32 s29, s7, 0
    ds_read_b128 v[124:127], v237 offset:0
    v_mfma_f32_16x16x32_bf16 v[20:23], a[164:167], a[20:23], v[20:23]
    ds_read_b128 v[132:135], v237 offset:13312
    v_mfma_f32_16x16x32_bf16 v[24:27], a[148:151], a[8:11], v[224:227]
    global_load_lds_dwordx4 v239, s[28:29] offset:-3072
    v_mfma_f32_16x16x32_bf16 v[24:27], a[164:167], a[24:27], v[24:27]
    s_waitcnt lgkmcnt(3)
    v_lshlrev_b32 v104, 16, v108
    v_and_b32 v105, 0xffff0000, v108
    v_mfma_f32_16x16x32_bf16 v[28:31], a[148:151], a[12:15], v[224:227]
    v_lshlrev_b32 v106, 16, v109
    v_and_b32 v107, 0xffff0000, v109
    v_mfma_f32_16x16x32_bf16 v[28:31], a[164:167], a[28:31], v[28:31]
    global_load_lds_dwordx4 v239, s[28:29] offset:-2048
    v_lshlrev_b32 v108, 16, v110
    v_mfma_f32_16x16x32_bf16 v[32:35], a[216:219], a[0:3], v[224:227]
    v_and_b32 v109, 0xffff0000, v110
    v_lshlrev_b32 v110, 16, v111
    v_mfma_f32_16x16x32_bf16 v[32:35], a[144:147], a[16:19], v[32:35]
    s_waitcnt lgkmcnt(2)
    v_and_b32 v111, 0xffff0000, v111
    v_lshlrev_b32 v112, 16, v116
    v_mfma_f32_16x16x32_bf16 v[36:39], a[216:219], a[4:7], v[224:227]
    global_load_lds_dwordx4 v239, s[28:29] offset:-1024
    v_and_b32 v113, 0xffff0000, v116
    v_mfma_f32_16x16x32_bf16 v[36:39], a[144:147], a[20:23], v[36:39]
    v_lshlrev_b32 v114, 16, v117
    v_and_b32 v115, 0xffff0000, v117
    v_mfma_f32_16x16x32_bf16 v[40:43], a[216:219], a[8:11], v[224:227]
    v_lshlrev_b32 v116, 16, v118
    v_and_b32 v117, 0xffff0000, v118
    v_mfma_f32_16x16x32_bf16 v[40:43], a[144:147], a[24:27], v[40:43]
    global_load_lds_dwordx4 v239, s[28:29] offset:0
    v_lshlrev_b32 v118, 16, v119
    v_mfma_f32_16x16x32_bf16 v[44:47], a[216:219], a[12:15], v[224:227]
    s_waitcnt lgkmcnt(1)
    v_and_b32 v119, 0xffff0000, v119
    v_lshlrev_b32 v120, 16, v124
    v_mfma_f32_16x16x32_bf16 v[44:47], a[144:147], a[28:31], v[44:47]
    v_and_b32 v121, 0xffff0000, v124
    v_lshlrev_b32 v122, 16, v125
    v_mfma_f32_16x16x32_bf16 v[48:51], a[160:163], a[0:3], v[224:227]
    global_load_lds_dwordx4 v239, s[28:29] offset:1024
    v_and_b32 v123, 0xffff0000, v125
    v_mfma_f32_16x16x32_bf16 v[48:51], a[204:207], a[16:19], v[48:51]
    v_lshlrev_b32 v124, 16, v126
    v_and_b32 v125, 0xffff0000, v126
    v_mfma_f32_16x16x32_bf16 v[52:55], a[160:163], a[4:7], v[224:227]
    v_lshlrev_b32 v126, 16, v127
    v_and_b32 v127, 0xffff0000, v127
    v_mfma_f32_16x16x32_bf16 v[52:55], a[204:207], a[20:23], v[52:55]
    s_waitcnt lgkmcnt(0)
    global_load_lds_dwordx4 v239, s[28:29] offset:2048
    v_lshlrev_b32 v128, 16, v132
    v_mfma_f32_16x16x32_bf16 v[56:59], a[160:163], a[8:11], v[224:227]
    v_and_b32 v129, 0xffff0000, v132
    v_lshlrev_b32 v130, 16, v133
    v_mfma_f32_16x16x32_bf16 v[56:59], a[204:207], a[24:27], v[56:59]
    v_and_b32 v131, 0xffff0000, v133
    v_lshlrev_b32 v132, 16, v134
    v_mfma_f32_16x16x32_bf16 v[60:63], a[160:163], a[12:15], v[224:227]
    s_mov_b32 exec_hi, 0
    global_load_lds_dwordx4 v239, s[28:29] offset:3072
    s_mov_b32 exec_hi, -1
    v_mfma_f32_16x16x32_bf16 v[60:63], a[204:207], a[28:31], v[60:63]
    s_add_u32 m0, s35, 69632
    v_and_b32 v133, 0xffff0000, v134
    v_lshlrev_b32 v134, 16, v135
    v_mfma_f32_16x16x32_bf16 v[64:67], a[252:255], a[0:3], v[224:227]
    s_add_u32 s28, s6, 136192
    v_and_b32 v135, 0xffff0000, v135
    s_addc_u32 s29, s7, 0
    v_mfma_f32_16x16x32_bf16 v[64:67], a[156:159], a[16:19], v[64:67]
    global_load_lds_dwordx4 v239, s[28:29] offset:-3072
    v_mfma_f32_16x16x32_bf16 v[68:71], a[252:255], a[4:7], v[224:227]
    v_mfma_f32_16x16x32_bf16 v[68:71], a[156:159], a[20:23], v[68:71]
    v_mfma_f32_16x16x32_bf16 v[72:75], a[252:255], a[8:11], v[224:227]
    global_load_lds_dwordx4 v239, s[28:29] offset:-2048
    v_mfma_f32_16x16x32_bf16 v[72:75], a[156:159], a[24:27], v[72:75]
    v_mfma_f32_16x16x32_bf16 v[76:79], a[252:255], a[12:15], v[224:227]
    v_mfma_f32_16x16x32_bf16 v[76:79], a[156:159], a[28:31], v[76:79]
    global_load_lds_dwordx4 v239, s[28:29] offset:-1024
    v_mfma_f32_16x16x32_bf16 v[80:83], a[192:195], a[0:3], v[224:227]
    v_mfma_f32_16x16x32_bf16 v[80:83], a[240:243], a[16:19], v[80:83]
    v_mfma_f32_16x16x32_bf16 v[84:87], a[192:195], a[4:7], v[224:227]
    global_load_lds_dwordx4 v239, s[28:29] offset:0
    v_mfma_f32_16x16x32_bf16 v[84:87], a[240:243], a[20:23], v[84:87]
    v_mfma_f32_16x16x32_bf16 v[88:91], a[192:195], a[8:11], v[224:227]
    s_waitcnt vmcnt(11)
    s_barrier
    v_mfma_f32_16x16x32_bf16 v[88:91], a[240:243], a[24:27], v[88:91]
    global_load_lds_dwordx4 v239, s[28:29] offset:1024
    ds_read_b128 v[140:143], v236 offset:2048
    v_mfma_f32_16x16x32_bf16 v[92:95], a[192:195], a[12:15], v[224:227]
    ds_read_b128 v[148:151], v236 offset:15360
    v_mfma_f32_16x16x32_bf16 v[92:95], a[240:243], a[28:31], v[92:95]
    ds_read_b128 v[156:159], v237 offset:2048
    v_mfma_f32_16x16x32_bf16 v[96:99], a[152:155], a[0:3], v[224:227]
    global_load_lds_dwordx4 v239, s[28:29] offset:2048
    ds_read_b128 v[164:167], v237 offset:15360
    v_mfma_f32_16x16x32_bf16 v[96:99], a[168:171], a[16:19], v[96:99]
    ds_read_b128 a[0:3], v214 offset:2048
    v_mfma_f32_16x16x32_bf16 v[100:103], a[152:155], a[4:7], v[224:227]
    s_waitcnt lgkmcnt(4)
    ds_read_b128 a[16:19], v216 offset:2048
    v_lshlrev_b32 v136, 16, v140
    v_mfma_f32_16x16x32_bf16 v[100:103], a[168:171], a[20:23], v[100:103]
    s_mov_b32 exec_hi, 0
    global_load_lds_dwordx4 v239, s[28:29] offset:3072
    s_mov_b32 exec_hi, -1
    v_mfma_f32_16x16x32_bf16 v[0:3], a[172:175], a[32:35], v[0:3]
    s_add_u32 m0, s35, 82944
    ds_read_b128 a[4:7], v214 offset:15360
    v_and_b32 v137, 0xffff0000, v140
    v_mfma_f32_16x16x32_bf16 v[0:3], a[196:199], a[48:51], v[0:3]
    s_add_u32 s28, s6, 162816
    ds_read_b128 a[20:23], v216 offset:15360
    v_lshlrev_b32 v138, 16, v141
    v_mfma_f32_16x16x32_bf16 v[4:7], a[172:175], a[36:39], v[4:7]
    s_addc_u32 s29, s7, 0
    ds_read_b128 a[8:11], v215 offset:2048
    v_and_b32 v139, 0xffff0000, v141
    v_mfma_f32_16x16x32_bf16 v[4:7], a[196:199], a[52:55], v[4:7]
    global_load_lds_dwordx4 v239, s[28:29] offset:-3072
    ds_read_b128 a[24:27], v218 offset:2048
    v_mfma_f32_16x16x32_bf16 v[8:11], a[172:175], a[40:43], v[8:11]
    ds_read_b128 a[12:15], v215 offset:15360
    v_lshlrev_b32 v140, 16, v142
    v_mfma_f32_16x16x32_bf16 v[8:11], a[196:199], a[56:59], v[8:11]
    ds_read_b128 a[28:31], v218 offset:15360
    v_and_b32 v141, 0xffff0000, v142
    v_mfma_f32_16x16x32_bf16 v[12:15], a[172:175], a[44:47], v[12:15]
    global_load_lds_dwordx4 v239, s[28:29] offset:-2048
    ds_read_b128 v[172:175], v236 offset:4096
    v_mfma_f32_16x16x32_bf16 v[12:15], a[196:199], a[60:63], v[12:15]
    ds_read_b128 v[180:183], v236 offset:17408
    v_lshlrev_b32 v142, 16, v143
    v_mfma_f32_16x16x32_bf16 v[16:19], a[220:223], a[32:35], v[16:19]
    ds_read_b128 v[188:191], v237 offset:4096
    v_and_b32 v143, 0xffff0000, v143
    v_mfma_f32_16x16x32_bf16 v[16:19], a[244:247], a[48:51], v[16:19]
    global_load_lds_dwordx4 v239, s[28:29] offset:-1024
    ds_read_b128 v[196:199], v237 offset:17408
    v_mfma_f32_16x16x32_bf16 v[20:23], a[220:223], a[36:39], v[20:23]
    s_waitcnt lgkmcnt(14)
    ds_read_b64 v[202:203], v238 offset:6144
    v_lshlrev_b32 v144, 16, v148
    v_mfma_f32_16x16x32_bf16 v[20:23], a[244:247], a[52:55], v[20:23]
    ds_read_b64 v[206:207], v238 offset:19456
    v_and_b32 v145, 0xffff0000, v148
    v_mfma_f32_16x16x32_bf16 v[24:27], a[220:223], a[40:43], v[24:27]
    global_load_lds_dwordx4 v239, s[28:29] offset:0
    v_lshlrev_b32 v146, 16, v149
    v_mfma_f32_16x16x32_bf16 v[24:27], a[244:247], a[56:59], v[24:27]
    v_and_b32 v147, 0xffff0000, v149
    v_lshlrev_b32 v148, 16, v150
    v_mfma_f32_16x16x32_bf16 v[28:31], a[220:223], a[44:47], v[28:31]
    v_and_b32 v149, 0xffff0000, v150
    v_lshlrev_b32 v150, 16, v151
    v_mfma_f32_16x16x32_bf16 v[28:31], a[244:247], a[60:63], v[28:31]
    global_load_lds_dwordx4 v239, s[28:29] offset:1024
    v_and_b32 v151, 0xffff0000, v151
    v_mfma_f32_16x16x32_bf16 v[32:35], a[188:191], a[32:35], v[32:35]
    s_waitcnt lgkmcnt(14)
    v_lshlrev_b32 v152, 16, v156
    v_and_b32 v153, 0xffff0000, v156
    v_mfma_f32_16x16x32_bf16 v[32:35], a[212:215], a[48:51], v[32:35]
    v_lshlrev_b32 v154, 16, v157
    v_and_b32 v155, 0xffff0000, v157
    v_mfma_f32_16x16x32_bf16 v[36:39], a[188:191], a[36:39], v[36:39]
    global_load_lds_dwordx4 v239, s[28:29] offset:2048
    v_lshlrev_b32 v156, 16, v158
    v_mfma_f32_16x16x32_bf16 v[36:39], a[212:215], a[52:55], v[36:39]
    v_and_b32 v157, 0xffff0000, v158
    v_lshlrev_b32 v158, 16, v159
    v_mfma_f32_16x16x32_bf16 v[40:43], a[188:191], a[40:43], v[40:43]
    s_waitcnt vmcnt(13)
    s_barrier
    v_mfma_f32_16x16x32_bf16 v[40:43], a[212:215], a[56:59], v[40:43]
    s_mov_b32 exec_hi, 0
    global_load_lds_dwordx4 v239, s[28:29] offset:3072
    s_mov_b32 exec_hi, -1
    v_mfma_f32_16x16x32_bf16 v[44:47], a[188:191], a[44:47], v[44:47]
    s_add_u32 m0, s35, 96256
    ds_read_b64_tr_b16 a[180:181], v253 offset:0
    v_and_b32 v159, 0xffff0000, v159
    v_mfma_f32_16x16x32_bf16 v[44:47], a[212:215], a[60:63], v[44:47]
    s_add_u32 s28, s6, 189440
    ds_read_b64_tr_b16 a[182:183], v253 offset:3328
    v_lshlrev_b32 v160, 16, v164
    v_mfma_f32_16x16x32_bf16 v[48:51], a[236:239], a[32:35], v[48:51]
    s_addc_u32 s29, s7, 0
    ds_read_b64_tr_b16 a[228:229], v253 offset:8
    v_and_b32 v161, 0xffff0000, v164
    v_mfma_f32_16x16x32_bf16 v[48:51], a[184:187], a[48:51], v[48:51]
    global_load_lds_dwordx4 v239, s[28:29] offset:-3072
    ds_read_b64_tr_b16 a[230:231], v253 offset:3336
    v_mfma_f32_16x16x32_bf16 v[52:55], a[236:239], a[36:39], v[52:55]
    ds_read_b64_tr_b16 a[148:149], v253 offset:256
    v_lshlrev_b32 v162, 16, v165
    v_mfma_f32_16x16x32_bf16 v[52:55], a[184:187], a[52:55], v[52:55]
    ds_read_b64_tr_b16 a[150:151], v253 offset:3584
    v_and_b32 v163, 0xffff0000, v165
    v_mfma_f32_16x16x32_bf16 v[56:59], a[236:239], a[40:43], v[56:59]
    global_load_lds_dwordx4 v239, s[28:29] offset:-2048
    ds_read_b64_tr_b16 a[164:165], v253 offset:264
    v_mfma_f32_16x16x32_bf16 v[56:59], a[184:187], a[56:59], v[56:59]
    ds_read_b64_tr_b16 a[166:167], v253 offset:3592
    v_lshlrev_b32 v164, 16, v166
    v_mfma_f32_16x16x32_bf16 v[60:63], a[236:239], a[44:47], v[60:63]
    ds_read_b64_tr_b16 a[216:217], v253 offset:512
    v_and_b32 v165, 0xffff0000, v166
    v_mfma_f32_16x16x32_bf16 v[60:63], a[184:187], a[60:63], v[60:63]
    global_load_lds_dwordx4 v239, s[28:29] offset:-1024
    ds_read_b64_tr_b16 a[218:219], v253 offset:3840
    v_mfma_f32_16x16x32_bf16 v[64:67], a[208:211], a[32:35], v[64:67]
    ds_read_b64_tr_b16 a[144:145], v253 offset:520
    v_lshlrev_b32 v166, 16, v167
    v_mfma_f32_16x16x32_bf16 v[64:67], a[232:235], a[48:51], v[64:67]
    ds_read_b64_tr_b16 a[146:147], v253 offset:3848
    v_and_b32 v167, 0xffff0000, v167
    v_mfma_f32_16x16x32_bf16 v[68:71], a[208:211], a[36:39], v[68:71]
    global_load_lds_dwordx4 v239, s[28:29] offset:0
    ds_read_b64_tr_b16 a[160:161], v254 offset:0
    v_mfma_f32_16x16x32_bf16 v[68:71], a[232:235], a[52:55], v[68:71]
    s_waitcnt lgkmcnt(14)
    ds_read_b64_tr_b16 a[162:163], v254 offset:3328
    v_lshlrev_b32 v168, 16, v172
    v_mfma_f32_16x16x32_bf16 v[72:75], a[208:211], a[40:43], v[72:75]
    v_and_b32 v169, 0xffff0000, v172
    v_lshlrev_b32 v170, 16, v173
    v_mfma_f32_16x16x32_bf16 v[72:75], a[232:235], a[56:59], v[72:75]
    global_load_lds_dwordx4 v239, s[28:29] offset:1024
    v_and_b32 v171, 0xffff0000, v173
    v_mfma_f32_16x16x32_bf16 v[76:79], a[208:211], a[44:47], v[76:79]
    v_lshlrev_b32 v172, 16, v174
    v_and_b32 v173, 0xffff0000, v174
    v_mfma_f32_16x16x32_bf16 v[76:79], a[232:235], a[60:63], v[76:79]
    v_lshlrev_b32 v174, 16, v175
    v_and_b32 v175, 0xffff0000, v175
    v_mfma_f32_16x16x32_bf16 v[80:83], a[176:179], a[32:35], v[80:83]
    global_load_lds_dwordx4 v239, s[28:29] offset:2048
    v_lshlrev_b32 v176, 16, v180
    v_mfma_f32_16x16x32_bf16 v[80:83], a[200:203], a[48:51], v[80:83]
    s_waitcnt vmcnt(13) lgkmcnt(0)
    s_barrier
    v_mfma_f32_16x16x32_bf16 v[84:87], a[176:179], a[36:39], v[84:87]
    ds_read_b64_tr_b16 a[204:205], v253 offset:13312
    v_and_b32 v177, 0xffff0000, v180
    v_mfma_f32_16x16x32_bf16 v[84:87], a[200:203], a[52:55], v[84:87]
    s_mov_b32 exec_hi, 0
    global_load_lds_dwordx4 v239, s[28:29] offset:3072
    s_mov_b32 exec_hi, -1
    v_mfma_f32_16x16x32_bf16 v[88:91], a[176:179], a[40:43], v[88:91]
    s_add_u32 m0, s35, 56320
    ds_read_b64_tr_b16 a[206:207], v253 offset:16640
    v_lshlrev_b32 v178, 16, v181
    v_mfma_f32_16x16x32_bf16 v[88:91], a[200:203], a[56:59], v[88:91]
    s_add_u32 s28, s6, 216064
    ds_read_b64_tr_b16 a[252:253], v253 offset:13320
    v_and_b32 v179, 0xffff0000, v181
    v_mfma_f32_16x16x32_bf16 v[92:95], a[176:179], a[44:47], v[92:95]
    s_addc_u32 s29, s7, 0
    ds_read_b64_tr_b16 a[254:255], v253 offset:16648
    v_lshlrev_b32 v180, 16, v182
    v_mfma_f32_16x16x32_bf16 v[92:95], a[200:203], a[60:63], v[92:95]
    global_load_lds_dwordx4 v239, s[28:29] offset:-3072
    ds_read_b64_tr_b16 a[156:157], v253 offset:13568
    v_mfma_f32_16x16x32_bf16 v[96:99], a[224:227], a[32:35], v[96:99]
    ds_read_b64_tr_b16 a[158:159], v253 offset:16896
    v_and_b32 v181, 0xffff0000, v182
    v_mfma_f32_16x16x32_bf16 v[96:99], a[248:251], a[48:51], v[96:99]
    ds_read_b64_tr_b16 a[192:193], v253 offset:13576
    v_lshlrev_b32 v182, 16, v183
    v_mfma_f32_16x16x32_bf16 v[100:103], a[224:227], a[36:39], v[100:103]
    global_load_lds_dwordx4 v239, s[28:29] offset:-2048
    ds_read_b64_tr_b16 a[194:195], v253 offset:16904
    v_mfma_f32_16x16x32_bf16 v[100:103], a[248:251], a[52:55], v[100:103]
    ds_read_b64_tr_b16 a[240:241], v253 offset:13824
    v_and_b32 v183, 0xffff0000, v183
    v_mfma_f32_16x16x32_bf16 v[0:3], a[180:183], a[0:3], v[0:3]
    s_waitcnt lgkmcnt(7)
    ds_read_b64_tr_b16 a[242:243], v253 offset:17152
    v_lshlrev_b32 v184, 16, v188
    v_mfma_f32_16x16x32_bf16 v[0:3], a[204:207], a[16:19], v[0:3]
    global_load_lds_dwordx4 v239, s[28:29] offset:-1024
    ds_read_b64_tr_b16 a[152:153], v253 offset:13832
    v_mfma_f32_16x16x32_bf16 v[4:7], a[180:183], a[4:7], v[4:7]
    ds_read_b64_tr_b16 a[154:155], v253 offset:17160
    v_and_b32 v185, 0xffff0000, v188
    v_mfma_f32_16x16x32_bf16 v[4:7], a[204:207], a[20:23], v[4:7]
    ds_read_b64_tr_b16 a[168:169], v254 offset:13312
    v_lshlrev_b32 v186, 16, v189
    v_mfma_f32_16x16x32_bf16 v[8:11], a[180:183], a[8:11], v[8:11]
    global_load_lds_dwordx4 v239, s[28:29] offset:0
    ds_read_b64_tr_b16 a[170:171], v254 offset:16640
    v_mfma_f32_16x16x32_bf16 v[8:11], a[204:207], a[24:27], v[8:11]
    ds_read_b128 a[32:35], v214 offset:3072
    v_and_b32 v187, 0xffff0000, v189
    v_mfma_f32_16x16x32_bf16 v[12:15], a[180:183], a[12:15], v[12:15]
    ds_read_b128 a[48:51], v216 offset:3072
    v_lshlrev_b32 v188, 16, v190
    v_mfma_f32_16x16x32_bf16 v[12:15], a[204:207], a[28:31], v[12:15]
    global_load_lds_dwordx4 v239, s[28:29] offset:1024
    ds_read_b128 a[36:39], v214 offset:16384
    v_mfma_f32_16x16x32_bf16 v[16:19], a[228:231], a[0:3], v[16:19]
    s_waitcnt lgkmcnt(13)
    ds_read_b128 a[52:55], v216 offset:16384
    v_and_b32 v189, 0xffff0000, v190
    v_mfma_f32_16x16x32_bf16 v[16:19], a[252:255], a[16:19], v[16:19]
    ds_read_b128 a[40:43], v215 offset:3072
    v_lshlrev_b32 v190, 16, v191
    v_mfma_f32_16x16x32_bf16 v[20:23], a[228:231], a[4:7], v[20:23]
    s_waitcnt vmcnt(12) lgkmcnt(5)
    s_barrier
    v_mfma_f32_16x16x32_bf16 v[20:23], a[252:255], a[20:23], v[20:23]
    global_load_lds_dwordx4 v239, s[28:29] offset:2048
    ds_read_b64_tr_b16 a[172:173], v253 offset:26624
    v_mfma_f32_16x16x32_bf16 v[24:27], a[228:231], a[8:11], v[24:27]
    ds_read_b64_tr_b16 a[174:175], v253 offset:29952
    v_and_b32 v191, 0xffff0000, v191
    v_mfma_f32_16x16x32_bf16 v[24:27], a[252:255], a[24:27], v[24:27]
    ds_read_b64_tr_b16 a[196:197], v253 offset:26632
    v_lshlrev_b32 v192, 16, v196
    v_mfma_f32_16x16x32_bf16 v[28:31], a[228:231], a[12:15], v[28:31]
    s_mov_b32 exec_hi, 0
    global_load_lds_dwordx4 v239, s[28:29] offset:3072
    s_mov_b32 exec_hi, -1
    v_mfma_f32_16x16x32_bf16 v[28:31], a[252:255], a[28:31], v[28:31]
    s_add_u32 m0, s35, 69632
    ds_read_b64_tr_b16 a[198:199], v253 offset:29960
    v_and_b32 v193, 0xffff0000, v196
    v_mfma_f32_16x16x32_bf16 v[32:35], a[148:151], a[0:3], v[32:35]
    s_add_u32 s28, s6, 242688
    ds_read_b64_tr_b16 a[220:221], v253 offset:26880
    v_lshlrev_b32 v194, 16, v197
    v_mfma_f32_16x16x32_bf16 v[32:35], a[156:159], a[16:19], v[32:35]
    s_addc_u32 s29, s7, 0
    ds_read_b64_tr_b16 a[222:223], v253 offset:30208
    v_and_b32 v195, 0xffff0000, v197
    v_mfma_f32_16x16x32_bf16 v[36:39], a[148:151], a[4:7], v[36:39]
    global_load_lds_dwordx4 v239, s[28:29] offset:-3072
    ds_read_b64_tr_b16 a[244:245], v253 offset:26888
    v_mfma_f32_16x16x32_bf16 v[36:39], a[156:159], a[20:23], v[36:39]
    ds_read_b64_tr_b16 a[246:247], v253 offset:30216
    v_lshlrev_b32 v196, 16, v198
    v_mfma_f32_16x16x32_bf16 v[40:43], a[148:151], a[8:11], v[40:43]
    ds_read_b64_tr_b16 a[188:189], v253 offset:27136
    v_and_b32 v197, 0xffff0000, v198
    v_mfma_f32_16x16x32_bf16 v[40:43], a[156:159], a[24:27], v[40:43]
    global_load_lds_dwordx4 v239, s[28:29] offset:-2048
    ds_read_b64_tr_b16 a[190:191], v253 offset:30464
    v_mfma_f32_16x16x32_bf16 v[44:47], a[148:151], a[12:15], v[44:47]
    ds_read_b64_tr_b16 a[212:213], v253 offset:27144
    v_lshlrev_b32 v198, 16, v199
    v_mfma_f32_16x16x32_bf16 v[44:47], a[156:159], a[28:31], v[44:47]
    ds_read_b64_tr_b16 a[214:215], v253 offset:30472
    v_and_b32 v199, 0xffff0000, v199
    v_mfma_f32_16x16x32_bf16 v[48:51], a[164:167], a[0:3], v[48:51]
    global_load_lds_dwordx4 v239, s[28:29] offset:-1024
    ds_read_b128 a[56:59], v218 offset:3072
    v_mfma_f32_16x16x32_bf16 v[48:51], a[192:195], a[16:19], v[48:51]
    ds_read_b64_tr_b16 a[236:237], v254 offset:26624
    v_lshlrev_b32 v200, 16, v202
    v_mfma_f32_16x16x32_bf16 v[52:55], a[164:167], a[4:7], v[52:55]
    ds_read_b64_tr_b16 a[238:239], v254 offset:29952
    v_and_b32 v201, 0xffff0000, v202
    v_mfma_f32_16x16x32_bf16 v[52:55], a[192:195], a[20:23], v[52:55]
    global_load_lds_dwordx4 v239, s[28:29] offset:0
    ds_read_b128 a[44:47], v215 offset:16384
    v_mfma_f32_16x16x32_bf16 v[56:59], a[164:167], a[8:11], v[56:59]
    ds_read_b128 a[60:63], v218 offset:16384
    v_lshlrev_b32 v202, 16, v203
    v_mfma_f32_16x16x32_bf16 v[56:59], a[192:195], a[24:27], v[56:59]
    ds_read_b128 a[64:67], v214 offset:4096
    v_and_b32 v203, 0xffff0000, v203
    v_mfma_f32_16x16x32_bf16 v[60:63], a[164:167], a[12:15], v[60:63]
    global_load_lds_dwordx4 v239, s[28:29] offset:1024
    ds_read_b128 a[80:83], v216 offset:4096
    v_mfma_f32_16x16x32_bf16 v[60:63], a[192:195], a[28:31], v[60:63]
    ds_read_b128 a[68:71], v214 offset:17408
    v_lshlrev_b32 v204, 16, v206
    v_mfma_f32_16x16x32_bf16 v[64:67], a[216:219], a[0:3], v[64:67]
    ds_read_b128 a[84:87], v216 offset:17408
    v_and_b32 v205, 0xffff0000, v206
    v_mfma_f32_16x16x32_bf16 v[64:67], a[240:243], a[16:19], v[64:67]
    global_load_lds_dwordx4 v239, s[28:29] offset:2048
    ds_read_b128 a[72:75], v215 offset:4096
    v_mfma_f32_16x16x32_bf16 v[68:71], a[216:219], a[4:7], v[68:71]
    s_waitcnt vmcnt(13) lgkmcnt(7)
    s_barrier
    v_mfma_f32_16x16x32_bf16 v[68:71], a[240:243], a[20:23], v[68:71]
    ds_read_b64_tr_b16 a[184:185], v253 offset:39936
    v_lshlrev_b32 v206, 16, v207
    v_mfma_f32_16x16x32_bf16 v[72:75], a[216:219], a[8:11], v[72:75]
    s_mov_b32 exec_hi, 0
    global_load_lds_dwordx4 v239, s[28:29] offset:3072
    s_mov_b32 exec_hi, -1
    v_mfma_f32_16x16x32_bf16 v[72:75], a[240:243], a[24:27], v[72:75]
    s_add_u32 m0, s35, 82944
    ds_read_b64_tr_b16 a[186:187], v253 offset:43264
    v_and_b32 v207, 0xffff0000, v207
    v_mfma_f32_16x16x32_bf16 v[76:79], a[216:219], a[12:15], v[76:79]
    s_add_u32 s28, s6, 269312
    ds_read_b64_tr_b16 a[208:209], v253 offset:39944
    v_lshlrev_b32 v224, 16, v208
    v_mfma_f32_16x16x32_bf16 v[76:79], a[240:243], a[28:31], v[76:79]
    s_addc_u32 s29, s7, 0
    ds_read_b64_tr_b16 a[210:211], v253 offset:43272
    v_and_b32 v225, 0xffff0000, v208
    v_mfma_f32_16x16x32_bf16 v[80:83], a[144:147], a[0:3], v[80:83]
    global_load_lds_dwordx4 v239, s[28:29] offset:-3072
    ds_read_b64_tr_b16 a[232:233], v253 offset:40192
    v_mfma_f32_16x16x32_bf16 v[80:83], a[152:155], a[16:19], v[80:83]
    ds_read_b64_tr_b16 a[234:235], v253 offset:43520
    v_add_f32 v224, 0xc11a0000, v224
    v_mfma_f32_16x16x32_bf16 v[84:87], a[144:147], a[4:7], v[84:87]
    ds_read_b64_tr_b16 a[176:177], v253 offset:40200
    v_add_f32 v225, 0xc11a0000, v225
    v_mfma_f32_16x16x32_bf16 v[84:87], a[152:155], a[20:23], v[84:87]
    global_load_lds_dwordx4 v239, s[28:29] offset:-2048
    ds_read_b64_tr_b16 a[178:179], v253 offset:43528
    v_mfma_f32_16x16x32_bf16 v[88:91], a[144:147], a[8:11], v[88:91]
    ds_read_b64_tr_b16 a[200:201], v253 offset:40448
    v_lshlrev_b32 v226, 16, v209
    v_mfma_f32_16x16x32_bf16 v[88:91], a[152:155], a[24:27], v[88:91]
    ds_read_b64_tr_b16 a[202:203], v253 offset:43776
    v_and_b32 v227, 0xffff0000, v209
    v_mfma_f32_16x16x32_bf16 v[92:95], a[144:147], a[12:15], v[92:95]
    global_load_lds_dwordx4 v239, s[28:29] offset:-1024
    ds_read_b64_tr_b16 a[224:225], v253 offset:40456
    v_mfma_f32_16x16x32_bf16 v[92:95], a[152:155], a[28:31], v[92:95]
    ds_read_b64_tr_b16 a[226:227], v253 offset:43784
    v_add_f32 v226, v224, v226
    v_mfma_f32_16x16x32_bf16 v[96:99], a[160:163], a[0:3], v[96:99]
    ds_read_b64_tr_b16 a[248:249], v254 offset:39936
    v_add_f32 v227, v225, v227
    v_mfma_f32_16x16x32_bf16 v[96:99], a[168:171], a[16:19], v[96:99]
    global_load_lds_dwordx4 v239, s[28:29] offset:0
    ds_read_b64_tr_b16 a[250:251], v254 offset:43264
    v_mfma_f32_16x16x32_bf16 v[100:103], a[160:163], a[4:7], v[100:103]
    ds_read_b128 a[88:91], v218 offset:4096
    v_lshlrev_b32 v228, 16, v210
    v_mfma_f32_16x16x32_bf16 v[100:103], a[168:171], a[20:23], v[100:103]
    ds_read_b128 a[76:79], v215 offset:17408
    v_and_b32 v229, 0xffff0000, v210
    v_mfma_f32_16x16x32_bf16 v[0:3], a[172:175], a[32:35], v[0:3]
    s_waitcnt lgkmcnt(14)
    global_load_lds_dwordx4 v239, s[28:29] offset:1024
    ds_read_b128 a[92:95], v218 offset:17408
    v_mfma_f32_16x16x32_bf16 v[0:3], a[184:187], a[48:51], v[0:3]
    ds_read_b128 a[96:99], v214 offset:5120
    v_add_f32 v228, v226, v228
    v_mfma_f32_16x16x32_bf16 v[4:7], a[172:175], a[36:39], v[4:7]
    ds_read_b128 a[112:115], v216 offset:5120
    v_add_f32 v229, v227, v229
    v_mfma_f32_16x16x32_bf16 v[4:7], a[184:187], a[52:55], v[4:7]
    global_load_lds_dwordx4 v239, s[28:29] offset:2048
    ds_read_b128 a[128:131], v214 offset:6144
    v_mfma_f32_16x16x32_bf16 v[8:11], a[172:175], a[40:43], v[8:11]
    ds_read_b128 a[100:103], v214 offset:18432
    v_lshlrev_b32 v230, 16, v211
    v_mfma_f32_16x16x32_bf16 v[8:11], a[184:187], a[56:59], v[8:11]
    ds_read_b128 a[116:119], v216 offset:18432
    v_and_b32 v231, 0xffff0000, v211
    v_mfma_f32_16x16x32_bf16 v[12:15], a[172:175], a[44:47], v[12:15]
    s_mov_b32 exec_hi, 0
    global_load_lds_dwordx4 v239, s[28:29] offset:3072
    s_mov_b32 exec_hi, -1
    v_mfma_f32_16x16x32_bf16 v[12:15], a[184:187], a[60:63], v[12:15]
    s_add_u32 m0, s35, 96256
    ds_read_b128 a[132:135], v214 offset:19456
    v_add_f32 v230, v228, v230
    v_mfma_f32_16x16x32_bf16 v[16:19], a[196:199], a[32:35], v[16:19]
    s_waitcnt vmcnt(14) lgkmcnt(9)
    s_barrier
    v_mfma_f32_16x16x32_bf16 v[16:19], a[208:211], a[48:51], v[16:19]
    s_add_u32 s28, s6, 295936
    ds_read_b64_tr_b16 a[180:181], v253 offset:0
    v_add_f32 v231, v229, v231
    v_mfma_f32_16x16x32_bf16 v[20:23], a[196:199], a[36:39], v[20:23]
    s_addc_u32 s29, s7, 0
    ds_read_b64_tr_b16 a[182:183], v253 offset:3328
    v_lshlrev_b32 v232, 16, v212
    v_mfma_f32_16x16x32_bf16 v[20:23], a[208:211], a[52:55], v[20:23]
    global_load_lds_dwordx4 v239, s[28:29] offset:-3072
    ds_read_b64_tr_b16 a[204:205], v253 offset:8
    v_mfma_f32_16x16x32_bf16 v[24:27], a[196:199], a[40:43], v[24:27]
    ds_read_b64_tr_b16 a[206:207], v253 offset:3336
    v_and_b32 v233, 0xffff0000, v212
    v_mfma_f32_16x16x32_bf16 v[24:27], a[208:211], a[56:59], v[24:27]
    ds_read_b64_tr_b16 a[228:229], v253 offset:256
    v_add_f32 v232, v230, v232
    v_mfma_f32_16x16x32_bf16 v[28:31], a[196:199], a[44:47], v[28:31]
    global_load_lds_dwordx4 v239, s[28:29] offset:-2048
    ds_read_b64_tr_b16 a[230:231], v253 offset:3584
    v_mfma_f32_16x16x32_bf16 v[28:31], a[208:211], a[60:63], v[28:31]
    ds_read_b64_tr_b16 a[252:253], v253 offset:264
    v_add_f32 v233, v231, v233
    v_mfma_f32_16x16x32_bf16 v[32:35], a[220:223], a[32:35], v[32:35]
    ds_read_b64_tr_b16 a[254:255], v253 offset:3592
    v_lshlrev_b32 v234, 16, v213
    v_mfma_f32_16x16x32_bf16 v[32:35], a[232:235], a[48:51], v[32:35]
    global_load_lds_dwordx4 v239, s[28:29] offset:-1024
    ds_read_b64_tr_b16 a[148:149], v253 offset:512
    v_mfma_f32_16x16x32_bf16 v[36:39], a[220:223], a[36:39], v[36:39]
    ds_read_b64_tr_b16 a[150:151], v253 offset:3840
    v_and_b32 v235, 0xffff0000, v213
    v_mfma_f32_16x16x32_bf16 v[36:39], a[232:235], a[52:55], v[36:39]
    ds_read_b64_tr_b16 a[156:157], v253 offset:520
    v_add_f32 v234, v232, v234
    v_mfma_f32_16x16x32_bf16 v[40:43], a[220:223], a[40:43], v[40:43]
    global_load_lds_dwordx4 v239, s[28:29] offset:0
    ds_read_b64_tr_b16 a[158:159], v253 offset:3848
    v_mfma_f32_16x16x32_bf16 v[40:43], a[232:235], a[56:59], v[40:43]
    ds_read_b64_tr_b16 a[164:165], v254 offset:0
    v_add_f32 v235, v233, v235
    v_mfma_f32_16x16x32_bf16 v[44:47], a[220:223], a[44:47], v[44:47]
    ds_read_b64_tr_b16 a[166:167], v254 offset:3328
    v_mfma_f32_16x16x32_bf16 v[44:47], a[232:235], a[60:63], v[44:47]
    global_load_lds_dwordx4 v239, s[28:29] offset:1024
    ds_read_b128 a[104:107], v215 offset:5120
    v_mfma_f32_16x16x32_bf16 v[48:51], a[244:247], a[32:35], v[48:51]
    ds_read_b128 a[120:123], v218 offset:5120
    v_mfma_f32_16x16x32_bf16 v[48:51], a[176:179], a[48:51], v[48:51]
    ds_read_b128 a[136:139], v215 offset:6144
    v_mfma_f32_16x16x32_bf16 v[52:55], a[244:247], a[36:39], v[52:55]
    global_load_lds_dwordx4 v239, s[28:29] offset:2048
    ds_read_b128 a[108:111], v215 offset:18432
    v_mfma_f32_16x16x32_bf16 v[52:55], a[176:179], a[52:55], v[52:55]
    ds_read_b128 a[124:127], v218 offset:18432
    v_mfma_f32_16x16x32_bf16 v[56:59], a[244:247], a[40:43], v[56:59]
    ds_read_b128 a[140:143], v215 offset:19456
    v_mfma_f32_16x16x32_bf16 v[56:59], a[176:179], a[56:59], v[56:59]
    s_mov_b32 exec_hi, 0
    global_load_lds_dwordx4 v239, s[28:29] offset:3072
    s_mov_b32 exec_hi, -1
    v_mfma_f32_16x16x32_bf16 v[60:63], a[244:247], a[44:47], v[60:63]
    v_mfma_f32_16x16x32_bf16 v[60:63], a[176:179], a[60:63], v[60:63]
    v_mfma_f32_16x16x32_bf16 v[64:67], a[188:191], a[32:35], v[64:67]
    s_mov_b64 exec, s[32:33]
    s_cbranch_execz L_skip_poll_b
    global_load_dword v221, v222, s[12:13] sc1
L_skip_poll_b:
    s_mov_b64 exec, -1
    v_mfma_f32_16x16x32_bf16 v[64:67], a[200:203], a[48:51], v[64:67]
    s_add_u32 m0, s35, 56320
    s_add_u32 s28, s6, 322560
    s_addc_u32 s29, s7, 0
    v_mfma_f32_16x16x32_bf16 v[68:71], a[188:191], a[36:39], v[68:71]
    s_waitcnt vmcnt(14) lgkmcnt(6)
    s_barrier
    v_mfma_f32_16x16x32_bf16 v[68:71], a[200:203], a[52:55], v[68:71]
    global_load_lds_dwordx4 v239, s[28:29] offset:-3072
    ds_read_b64_tr_b16 a[192:193], v253 offset:13312
    v_mfma_f32_16x16x32_bf16 v[72:75], a[188:191], a[40:43], v[72:75]
    ds_read_b64_tr_b16 a[194:195], v253 offset:16640
    v_mfma_f32_16x16x32_bf16 v[72:75], a[200:203], a[56:59], v[72:75]
    ds_read_b64_tr_b16 a[216:217], v253 offset:13320
    v_mfma_f32_16x16x32_bf16 v[76:79], a[188:191], a[44:47], v[76:79]
    global_load_lds_dwordx4 v239, s[28:29] offset:-2048
    ds_read_b64_tr_b16 a[218:219], v253 offset:16648
    v_mfma_f32_16x16x32_bf16 v[76:79], a[200:203], a[60:63], v[76:79]
    ds_read_b64_tr_b16 a[240:241], v253 offset:13568
    v_mfma_f32_16x16x32_bf16 v[80:83], a[212:215], a[32:35], v[80:83]
    ds_read_b64_tr_b16 a[242:243], v253 offset:16896
    v_mfma_f32_16x16x32_bf16 v[80:83], a[224:227], a[48:51], v[80:83]
    global_load_lds_dwordx4 v239, s[28:29] offset:-1024
    ds_read_b64_tr_b16 a[144:145], v253 offset:13576
    v_mfma_f32_16x16x32_bf16 v[84:87], a[212:215], a[36:39], v[84:87]
    ds_read_b64_tr_b16 a[146:147], v253 offset:16904
    v_mfma_f32_16x16x32_bf16 v[84:87], a[224:227], a[52:55], v[84:87]
    ds_read_b64_tr_b16 a[152:153], v253 offset:13824
    v_mfma_f32_16x16x32_bf16 v[88:91], a[212:215], a[40:43], v[88:91]
    global_load_lds_dwordx4 v239, s[28:29] offset:0
    ds_read_b64_tr_b16 a[154:155], v253 offset:17152
    v_mfma_f32_16x16x32_bf16 v[88:91], a[224:227], a[56:59], v[88:91]
    ds_read_b64_tr_b16 a[160:161], v253 offset:13832
    v_mfma_f32_16x16x32_bf16 v[92:95], a[212:215], a[44:47], v[92:95]
    ds_read_b64_tr_b16 a[162:163], v253 offset:17160
    v_mfma_f32_16x16x32_bf16 v[92:95], a[224:227], a[60:63], v[92:95]
    global_load_lds_dwordx4 v239, s[28:29] offset:1024
    ds_read_b64_tr_b16 a[168:169], v254 offset:13312
    v_mfma_f32_16x16x32_bf16 v[96:99], a[236:239], a[32:35], v[96:99]
    ds_read_b64_tr_b16 a[170:171], v254 offset:16640
    v_mfma_f32_16x16x32_bf16 v[96:99], a[248:251], a[48:51], v[96:99]
    v_mfma_f32_16x16x32_bf16 v[100:103], a[236:239], a[36:39], v[100:103]
    global_load_lds_dwordx4 v239, s[28:29] offset:2048
    v_mfma_f32_16x16x32_bf16 v[100:103], a[248:251], a[52:55], v[100:103]
    v_mfma_f32_16x16x32_bf16 v[0:3], a[180:183], a[64:67], v[0:3]
    s_waitcnt lgkmcnt(12)
    v_mfma_f32_16x16x32_bf16 v[0:3], a[192:195], a[80:83], v[0:3]
    s_mov_b32 exec_hi, 0
    global_load_lds_dwordx4 v239, s[28:29] offset:3072
    s_mov_b32 exec_hi, -1
    v_mfma_f32_16x16x32_bf16 v[4:7], a[180:183], a[68:71], v[4:7]
    s_add_u32 s36, s22, 0
    s_addc_u32 s37, s23, 0
    s_bfe_i32 s100, s0, 0x10000
    v_mfma_f32_16x16x32_bf16 v[4:7], a[192:195], a[84:87], v[4:7]
    s_and_b32 s101, s100, 0x7ff
    s_lshr_b32 s0, s0, 1
    v_mfma_f32_16x16x32_bf16 v[8:11], a[180:183], a[72:75], v[8:11]
    v_mfma_f32_16x16x32_bf16 v[8:11], a[192:195], a[88:91], v[8:11]
    v_mfma_f32_16x16x32_bf16 v[12:15], a[180:183], a[76:79], v[12:15]
    s_waitcnt vmcnt(14) lgkmcnt(0)
    s_barrier
    v_mfma_f32_16x16x32_bf16 v[12:15], a[192:195], a[92:95], v[12:15]
    ds_read_b64_tr_b16 a[172:173], v253 offset:26624
    v_mfma_f32_16x16x32_bf16 v[16:19], a[204:207], a[64:67], v[16:19]
    ds_read_b64_tr_b16 a[174:175], v253 offset:29952
    v_mfma_f32_16x16x32_bf16 v[16:19], a[216:219], a[80:83], v[16:19]
    ds_read_b64_tr_b16 a[184:185], v253 offset:26632
    v_mfma_f32_16x16x32_bf16 v[20:23], a[204:207], a[68:71], v[20:23]
    ds_read_b64_tr_b16 a[186:187], v253 offset:29960
    v_mfma_f32_16x16x32_bf16 v[20:23], a[216:219], a[84:87], v[20:23]
    ds_read_b64_tr_b16 a[196:197], v253 offset:26880
    v_mfma_f32_16x16x32_bf16 v[24:27], a[204:207], a[72:75], v[24:27]
    ds_read_b64_tr_b16 a[198:199], v253 offset:30208
    v_mfma_f32_16x16x32_bf16 v[24:27], a[216:219], a[88:91], v[24:27]
    ds_read_b64_tr_b16 a[208:209], v253 offset:26888
    v_mfma_f32_16x16x32_bf16 v[28:31], a[204:207], a[76:79], v[28:31]
    ds_read_b64_tr_b16 a[210:211], v253 offset:30216
    v_mfma_f32_16x16x32_bf16 v[28:31], a[216:219], a[92:95], v[28:31]
    ds_read_b64_tr_b16 a[220:221], v253 offset:27136
    v_mfma_f32_16x16x32_bf16 v[32:35], a[228:231], a[64:67], v[32:35]
    ds_read_b64_tr_b16 a[222:223], v253 offset:30464
    v_mfma_f32_16x16x32_bf16 v[32:35], a[240:243], a[80:83], v[32:35]
    ds_read_b64_tr_b16 a[232:233], v253 offset:27144
    v_mfma_f32_16x16x32_bf16 v[36:39], a[228:231], a[68:71], v[36:39]
    ds_read_b64_tr_b16 a[234:235], v253 offset:30472
    v_mfma_f32_16x16x32_bf16 v[36:39], a[240:243], a[84:87], v[36:39]
    ds_read_b64_tr_b16 a[244:245], v254 offset:26624
    v_mfma_f32_16x16x32_bf16 v[40:43], a[228:231], a[72:75], v[40:43]
    ds_read_b64_tr_b16 a[246:247], v254 offset:29952
    v_mfma_f32_16x16x32_bf16 v[40:43], a[240:243], a[88:91], v[40:43]
    s_branch L_join
L_slow:
    s_mov_b32 s46, m0
    s_mov_b32 s47, 0
L_slow_poll:
    s_sleep 8
    s_mov_b64 exec, s[32:33]
    s_cbranch_execz L_slow_skip
    global_load_dword v221, v222, s[12:13] sc1
L_slow_skip:
    s_mov_b64 exec, -1
    s_add_u32 s47, s47, 1
    s_waitcnt vmcnt(0)
    v_cmp_ne_u32 vcc, 27, v221
    s_nop 1
    s_cbranch_vccz L_slow_ret
    s_cmp_lt_u32 s47, 2000
    s_cbranch_scc1 L_slow_poll
    s_cmp_lg_u32 s16, 0
    s_cbranch_scc1 L_slow_ret
    v_mbcnt_lo_u32_b32 v236, -1, 0
    v_mbcnt_hi_u32_b32 v236, -1, v236
    v_lshrrev_b32 v237, 2, v236
    v_mul_u32_u24 v237, 832, v237
    v_and_b32 v208, 3, v236
    v_lshl_add_u32 v237, v208, 4, v237
    v_lshrrev_b32 v238, 4, v236
    v_bfe_u32 v209, v236, 2, 2
    v_lshl_add_u32 v238, v238, 3, v209
    v_lshlrev_b32 v238, 6, v238
    v_lshl_add_u32 v238, v208, 4, v238
    v_add_u32 v238, 159760, v238
    v_lshlrev_b32 v236, 4, v236
    s_mov_b32 s47, 169
L_slow_unit:
    s_mul_i32 s42, s47, 5042
    s_lshr_b32 s42, s42, 16
    s_mul_i32 s43, s42, 13
    s_sub_u32 s43, s47, s43
    s_mul_i32 s39, s42, 26624
    s_lshl_b32 s44, s43, 6
    s_add_u32 s39, s39, s44
    s_mul_i32 s44, s42, 5042
    s_lshr_b32 s44, s44, 16
    s_mul_i32 s45, s44, 13
    s_sub_u32 s42, s42, s45
    s_mul_i32 s40, s44, 352256
    s_and_b32 s44, s43, 3
    s_mul_i32 s44, s44, 79872
    s_lshr_b32 s45, s43, 2
    s_mul_i32 s45, s45, 26624
    s_add_u32 s44, s44, s45
    s_lshl_b32 s45, s42, 11
    s_add_u32 s44, s44, s45
    s_lshl_b32 s45, s42, 10
    s_add_u32 s45, s45, 319488
    s_cmp_lt_u32 s43, 12
    s_cselect_b32 s44, s44, s45
    s_cselect_b32 s41, 1, 13
    s_lshl_b32 s41, s41, 10
    s_add_u32 s40, s40, s44
    s_mov_b32 m0, 159760
    s_add_u32 s42, s6, s39
    s_addc_u32 s43, s7, 0
    global_load_lds_dwordx4 v237, s[42:43]
    s_mov_b32 m0, 160784
    s_add_u32 s42, s42, 13312
    s_addc_u32 s43, s43, 0
    global_load_lds_dwordx4 v237, s[42:43]
    s_waitcnt vmcnt(0)
    ds_read_b64_tr_b16 v[208:209], v238 offset:0
    ds_read_b64_tr_b16 v[210:211], v238 offset:256
    ds_read_b64_tr_b16 v[212:213], v238 offset:8
    ds_read_b64_tr_b16 v[214:215], v238 offset:264
    s_add_u32 s42, s14, s40
    s_addc_u32 s43, s15, 0
    s_add_u32 s44, s42, s41
    s_addc_u32 s45, s43, 0
    s_waitcnt lgkmcnt(0)
    global_store_dwordx4 v236, v[208:211], s[42:43] sc1
    global_store_dwordx4 v236, v[212:215], s[44:45] sc1
    s_add_u32 s47, s47, 1
    s_waitcnt vmcnt(0)
    s_cmp_lt_u32 s47, 1014
    s_cbranch_scc1 L_slow_unit
    s_mov_b32 m0, s46
L_slow_ret:
    s_branch L_slow_back
L_code_end:
.section .rodata,"a"
.p2align 6
.amdhsa_kernel standalone__dcn_v2_cross__recsys_kernel
  .amdhsa_next_free_vgpr 512
  .amdhsa_next_free_sgpr 102
  .amdhsa_accum_offset 256
  .amdhsa_group_segment_fixed_size 0
  .amdhsa_kernarg_size 48
  .amdhsa_user_sgpr_count 2
  .amdhsa_user_sgpr_kernarg_segment_ptr 1
  .amdhsa_system_sgpr_workgroup_id_x 1
  .amdhsa_float_denorm_mode_32 3
.end_amdhsa_kernel
```
